```python
import torch

def _softmax(x, axis=-1):
    return torch.softmax(x, dim=axis)
def _gelu(x):
    return torch.nn.functional.gelu(x, approximate="tanh")
def _silu(x):
    return torch.nn.functional.silu(x)
def _sigmoid(x):
    return torch.sigmoid(x)
def _layernorm(x, axis=-1, eps=1e-5):
    m = x.mean(dim=axis, keepdim=True)
    v = x.var(dim=axis, keepdim=True, unbiased=False)
    return (x - m) / torch.sqrt(v + eps)
def _scatter_add(tgt, idx, src, axis=0):
    return tgt.clone().index_add_(axis, idx, src)
def _segment_sum(src, seg, n):
    out = torch.zeros((n,) + src.shape[1:], dtype=src.dtype)
    return out.index_add_(0, seg, src)
def _pad(x, pw):
    flat = tuple(v for pair in reversed(pw) for v in pair)
    return torch.nn.functional.pad(x, flat)

kernel_name = 'standalone__adm_resblock__diffusion'

def setup_inputs():

    _w = (lambda a: (lambda t: t.to(torch.bfloat16) if t.is_floating_point() else t)(torch.as_tensor(a)))
    B, C, HW, E = 2, 512, 32, 768
    sc = (9.0 * C) ** -0.5
    return {
        "x": _w((lambda *s: torch.randn(*s, dtype=torch.bfloat16) * 0.05)(B, C, HW, HW)),
        "t_emb": _w((lambda *s: torch.randn(*s, dtype=torch.bfloat16) * 0.4)(B, E)),
        "g1": _w(1.0 + 0.1 * (lambda *s: torch.randn(*s, dtype=torch.bfloat16) * 0.4)(C)),
        "be1": _w(0.1 * (lambda *s: torch.randn(*s, dtype=torch.bfloat16) * 0.4)(C)),
        "w1": _w((lambda *s: torch.randn(*s, dtype=torch.bfloat16) * 0.4)(C, C, 3, 3) * sc),
        "w_emb": _w((lambda *s: torch.randn(*s, dtype=torch.bfloat16) * 0.4)(E, C) * (E ** -0.5)),
        "g2": _w(1.0 + 0.1 * (lambda *s: torch.randn(*s, dtype=torch.bfloat16) * 0.4)(C)),
        "be2": _w(0.1 * (lambda *s: torch.randn(*s, dtype=torch.bfloat16) * 0.4)(C)),
        "w2": _w((lambda *s: torch.randn(*s, dtype=torch.bfloat16) * 0.4)(C, C, 3, 3) * sc),
    }

def reference(x, t_emb, g1, be1, w1, w_emb, g2, be2, w2):
    B, C, H, W = x.shape
    G, eps = 4, 1e-5
    def gn(z, gamma, beta):
        zr = z.reshape(B, G, (C // G) * H * W)
        mu = zr.mean(-1).reshape(B, G, 1)
        var = ((zr - mu) ** 2).mean(-1).reshape(B, G, 1)
        zn = ((zr - mu) / torch.sqrt(var + eps)).reshape(B, C, H, W)
        return zn * gamma.reshape(1, C, 1, 1) + beta.reshape(1, C, 1, 1)
    def conv3(z, w):
        zp = _pad(z, ((0, 0), (0, 0), (1, 1), (1, 1)))
        taps = [torch.einsum("bchw,oc->bohw", zp[:, :, i:i+H, j:j+W], w[:, :, i, j]) for i in range(3) for j in range(3)]
        out = taps[0]
        for t in taps[1:]:
            out = out + t
        return out
    h = conv3(_silu(gn(x, g1, be1)), w1)
    emb = _silu(t_emb) @ w_emb
    h = h + emb.reshape(B, C, 1, 1)
    h = conv3(_silu(gn(h, g2, be2)), w2)
    return x + h
```

```asm
; @launch grid=(256,1,1) block=(256,1,1) lds=163840
.amdgcn_target "amdgcn-amd-amdhsa--gfx950"
.text
.globl standalone__adm_resblock__diffusion_kernel
.p2align 8
.type standalone__adm_resblock__diffusion_kernel,@function
standalone__adm_resblock__diffusion_kernel:
    s_cmp_ge_u32 s2, 256
    s_cbranch_scc1 L_exit
    s_load_dwordx16 s[32:47], s[0:1], 0
    s_load_dwordx8 s[48:55], s[0:1], 64
    v_lshrrev_b32 v232, 6, v0
    v_and_b32 v1, 63, v0
    v_readfirstlane_b32 s3, v232
    s_and_b32 s67, s2, 7
    s_lshr_b32 s68, s2, 3
    s_lshr_b32 s24, s67, 2
    s_and_b32 s25, s67, 3
    s_and_b32 s26, s68, 3
    s_lshr_b32 s27, s68, 2
    s_lshl_b32 s28, s25, 7
    s_lshl_b32 s69, s26, 5
    s_add_u32 s28, s28, s69
    s_lshl_b32 s29, s27, 2
    s_mov_b32 s56, 0x07060100
    s_mov_b32 s57, 0x05040302
    s_mov_b32 s30, 1
    s_getpc_b64 s[20:21]
L_pc:
    s_sub_u32 s20, s20, L_pc-standalone__adm_resblock__diffusion_kernel
    s_subb_u32 s21, s21, 0
    s_mov_b32 s22, L_code_end-standalone__adm_resblock__diffusion_kernel
    s_mov_b32 s23, 0x00020000
    v_lshlrev_b32 v246, 4, v0
    s_mov_b32 m0, 147456
    s_movk_i32 s68, 4096
    s_movk_i32 s69, 8192
    s_movk_i32 s70, 12288
    buffer_load_dwordx4 v246, s[20:23], 0 offen lds
    buffer_load_dwordx4 v246, s[20:23], s68 offen lds
    buffer_load_dwordx4 v246, s[20:23], s69 offen lds
    buffer_load_dwordx4 v246, s[20:23], s70 offen lds
    s_lshl_b32 s67, s24, 20
    s_lshl_b32 s68, s3, 3
    s_add_u32 s68, s68, s28
    s_lshl_b32 s68, s68, 11
    s_add_u32 s67, s67, s68
    s_lshl_b32 s68, s29, 6
    s_add_u32 s67, s67, s68
    v_lshlrev_b32 v15, 2, v1
    v_add_u32 v15, s67, v15
    s_and_b32 s67, s3, 1
    s_lshl_b32 s67, s67, 3
    v_lshrrev_b32 v232, 3, v1
    v_add_u32 v232, s67, v232
    v_lshrrev_b32 v233, 1, v232
    v_lshrrev_b32 v234, 3, v232
    v_xor_b32 v234, v234, v232
    v_and_b32 v234, 1, v234
    v_lshl_add_u32 v234, v234, 3, v233
    v_and_b32 v235, 7, v1
    v_xor_b32 v235, v235, v233
    v_mul_u32_u24 v2, 9216, v234
    v_lshl_add_u32 v2, v235, 4, v2
    s_lshr_b32 s68, s3, 1
    s_mul_i32 s69, s68, 1152
    s_add_u32 s69, s69, 4096
    v_add_u32 v2, s69, v2
    s_mul_i32 s63, s28, 9216
    s_add_u32 s63, s63, 4096
    s_mul_i32 s61, s3, 9216
    s_mov_b32 s7, 0x00020000
    v_add_u32 v16, -896, v2
    v_add_u32 v17, -1792, v2
    v_add_u32 v18, -2688, v2
    v_add_u32 v19, 512, v2
    v_add_u32 v20, -384, v2
    v_add_u32 v21, -1280, v2
    v_add_u32 v22, -2176, v2
    v_add_u32 v23, 1024, v2
    v_lshrrev_b32 v244, 4, v1
    v_and_b32 v245, 15, v1
    v_lshlrev_b32 v244, 9, v244
    v_lshl_add_u32 v244, v245, 4, v244
    v_mov_b32 v104, -1
    v_mov_b32 v105, -1
    v_mov_b32 v106, -1
    v_mov_b32 v107, -1
    s_waitcnt lgkmcnt(0)
    s_mov_b32 s12, s32
    s_mov_b32 s13, s33
    s_mov_b32 s14, 2097152
    s_mov_b32 s15, 0x00020000
    s_movk_i32 s68, 4096
    s_movk_i32 s69, 8192
    s_movk_i32 s70, 12288
    buffer_load_dword v248, v15, s[12:15], 0 offen offset:0
    buffer_load_dword v249, v15, s[12:15], 0 offen offset:2048
    buffer_load_dword v250, v15, s[12:15], s68 offen offset:0
    buffer_load_dword v251, v15, s[12:15], s68 offen offset:2048
    buffer_load_dword v252, v15, s[12:15], s69 offen offset:0
    buffer_load_dword v253, v15, s[12:15], s69 offen offset:2048
    buffer_load_dword v254, v15, s[12:15], s70 offen offset:0
    buffer_load_dword v255, v15, s[12:15], s70 offen offset:2048
    s_sub_u32 s40, s40, 8192
    s_subb_u32 s41, s41, 0
    s_sub_u32 s48, s48, 8192
    s_subb_u32 s49, s49, 0
    s_lshl_b32 s67, s24, 8
    s_add_u32 s67, s67, 8978432
    s_add_u32 s68, s54, s67
    s_addc_u32 s69, s55, 0
    s_load_dword s30, s[68:69], 0
    s_mov_b32 s16, s54
    s_mov_b32 s17, s55
    s_mov_b32 s18, 16777216
    s_mov_b32 s19, 0x00020000
    s_lshr_b32 s0, s28, 3
    s_add_u32 s0, s0, s3
    s_lshl_b32 s0, s0, 14
    s_lshl_b32 s68, s24, 20
    s_add_u32 s0, s0, s68
    s_lshl_b32 s68, s29, 9
    s_add_u32 s0, s0, s68
    buffer_store_dwordx4 v[104:107], v244, s[16:19], s0 offen sc1
    buffer_store_dwordx4 v[104:107], v244, s[16:19], s0 offen offset:256 sc1
    s_mov_b32 s8, s34
    s_mov_b32 s9, s35
    s_mov_b32 s10, 3072
    s_mov_b32 s11, 0x00020000
    s_mov_b32 s20, s42
    s_mov_b32 s21, s43
    s_mov_b32 s22, 786432
    s_mov_b32 s23, 0x00020000
    s_lshl_b32 s67, s27, 2
    s_add_u32 s67, s67, s3
    s_mul_i32 s67, s67, 24
    v_lshrrev_b32 v44, 4, v1
    v_mul_u32_u24 v44, 6, v44
    v_add_u32 v44, s67, v44
    s_mul_i32 s68, s24, 1536
    v_lshlrev_b32 v45, 1, v44
    buffer_load_dwordx3 v[40:42], v45, s[8:11], s68 offen
    v_lshlrev_b32 v47, 10, v44
    v_and_b32 v46, 15, v1
    v_lshl_add_u32 v47, v46, 2, v47
    s_lshl_b32 s68, s28, 1
    s_add_u32 s69, s68, 3072
    buffer_load_dword v32, v47, s[20:23], s68 offen offset:0
    buffer_load_dword v33, v47, s[20:23], s68 offen offset:1024
    buffer_load_dword v34, v47, s[20:23], s68 offen offset:2048
    buffer_load_dword v35, v47, s[20:23], s69 offen offset:0
    buffer_load_dword v36, v47, s[20:23], s69 offen offset:1024
    buffer_load_dword v37, v47, s[20:23], s69 offen offset:2048
    s_mov_b32 s35, s0
    s_mov_b32 s4, s40
    s_mov_b32 s5, s41
    s_mov_b32 s6, 4726784
    s_lshl_b32 s67, s27, 2
    s_add_u32 s67, s67, s3
    s_add_u32 s67, s67, s28
    s_mul_i32 s67, s67, 9216
    s_add_u32 s67, s67, 8192
    v_lshlrev_b32 v246, 4, v1
    s_mov_b32 m0, 147456
    s_nop 0
    buffer_load_dwordx4 v246, s[4:7], s67 offen offset:0 lds
    buffer_load_dwordx4 v246, s[4:7], s67 offen offset:1024 lds
    buffer_load_dwordx4 v246, s[4:7], s67 offen offset:2048 lds
    v_lshlrev_b32 v14, 4, v1
    s_lshl_b32 s67, s3, 3
    s_add_u32 s67, s67, s28
    s_lshl_b32 s67, s67, 1
    s_add_u32 s68, s36, s67
    s_addc_u32 s69, s37, 0
    s_add_u32 s70, s38, s67
    s_addc_u32 s71, s39, 0
    s_load_dwordx4 s[80:83], s[68:69], 0
    s_load_dwordx4 s[88:91], s[70:71], 0
    v_and_b32 v232, 15, v1
    v_lshrrev_b32 v233, 2, v232
    v_lshrrev_b32 v234, 3, v232
    v_xor_b32 v233, v233, v234
    v_and_b32 v233, 1, v233
    v_and_b32 v234, 7, v232
    v_lshl_add_u32 v233, v234, 1, v233
    v_lshrrev_b32 v239, 3, v233
    v_mul_u32_u24 v239, 9216, v239
    v_and_b32 v233, 7, v233
    v_lshl_add_u32 v233, v233, 7, v239
    s_lshr_b32 s68, s3, 1
    s_mul_i32 s69, s68, 9216
    v_add_u32 v233, s69, v233
    v_lshrrev_b32 v235, 4, v1
    v_mul_u32_u24 v236, 9, v235
    s_mul_i32 s67, s3, 36
    v_add_u32 v236, s67, v236
    v_add_u32 v237, 0, v236
    v_lshrrev_b32 v238, 3, v237
    v_and_b32 v237, 7, v237
    v_xor_b32 v237, v237, v234
    v_lshl_add_u32 v238, v238, 10, v233
    v_lshl_add_u32 v3, v237, 4, v238
    v_add_u32 v24, 73728, v3
    v_add_u32 v237, 1, v236
    v_lshrrev_b32 v238, 3, v237
    v_and_b32 v237, 7, v237
    v_xor_b32 v237, v237, v234
    v_lshl_add_u32 v238, v238, 10, v233
    v_lshl_add_u32 v4, v237, 4, v238
    v_add_u32 v25, 73728, v4
    v_add_u32 v237, 2, v236
    v_lshrrev_b32 v238, 3, v237
    v_and_b32 v237, 7, v237
    v_xor_b32 v237, v237, v234
    v_lshl_add_u32 v238, v238, 10, v233
    v_lshl_add_u32 v5, v237, 4, v238
    v_add_u32 v26, 73728, v5
    v_add_u32 v237, 3, v236
    v_lshrrev_b32 v238, 3, v237
    v_and_b32 v237, 7, v237
    v_xor_b32 v237, v237, v234
    v_lshl_add_u32 v238, v238, 10, v233
    v_lshl_add_u32 v6, v237, 4, v238
    v_add_u32 v27, 73728, v6
    v_add_u32 v237, 4, v236
    v_lshrrev_b32 v238, 3, v237
    v_and_b32 v237, 7, v237
    v_xor_b32 v237, v237, v234
    v_lshl_add_u32 v238, v238, 10, v233
    v_lshl_add_u32 v7, v237, 4, v238
    v_add_u32 v28, 73728, v7
    v_add_u32 v237, 5, v236
    v_lshrrev_b32 v238, 3, v237
    v_and_b32 v237, 7, v237
    v_xor_b32 v237, v237, v234
    v_lshl_add_u32 v238, v238, 10, v233
    v_lshl_add_u32 v8, v237, 4, v238
    v_add_u32 v29, 73728, v8
    v_add_u32 v237, 6, v236
    v_lshrrev_b32 v238, 3, v237
    v_and_b32 v237, 7, v237
    v_xor_b32 v237, v237, v234
    v_lshl_add_u32 v238, v238, 10, v233
    v_lshl_add_u32 v9, v237, 4, v238
    v_add_u32 v30, 73728, v9
    v_add_u32 v237, 7, v236
    v_lshrrev_b32 v238, 3, v237
    v_and_b32 v237, 7, v237
    v_xor_b32 v237, v237, v234
    v_lshl_add_u32 v238, v238, 10, v233
    v_lshl_add_u32 v10, v237, 4, v238
    v_add_u32 v31, 73728, v10
    v_and_b32 v232, 15, v1
    v_lshrrev_b32 v235, 4, v1
    v_lshlrev_b32 v11, 4, v232
    v_lshl_add_u32 v11, v235, 14, v11
    s_lshl_b32 s67, s3, 16
    s_lshl_b32 s68, s29, 9
    s_add_u32 s67, s67, s68
    v_add_u32 v11, s67, v11
    s_cmp_eq_u32 s27, 0
    s_cselect_b32 s67, 0x40000000, -512
    v_add_u32 v12, s67, v11
    s_cmp_eq_u32 s27, 7
    s_cselect_b32 s67, 0x40000000, 2048
    v_add_u32 v13, s67, v11
    v_and_b32 v232, 15, v1
    v_lshrrev_b32 v233, 4, v1
    v_bfe_u32 v234, v232, 1, 2
    v_xor_b32 v235, v234, v233
    s_mul_i32 s67, s3, 8704
    s_add_u32 s67, s67, 73728
    v_lshlrev_b32 v238, 6, v232
    v_add_u32 v239, s67, v238
    v_lshl_add_u32 v236, v235, 4, v239
    v_accvgpr_write_b32 a65, v236
    v_mul_u32_u24 v233, 2176, v233
    v_add_u32 v233, v233, v238
    s_lshr_b32 s67, s3, 1
    s_mul_i32 s67, s67, 36864
    s_add_u32 s67, s67, 73728
    v_add_u32 v233, s67, v233
    s_and_b32 s67, s3, 1
    s_lshl_b32 s67, s67, 1
    v_xor_b32 v234, s67, v234
    v_lshl_add_u32 v240, v234, 4, v233
    v_xor_b32 v234, 1, v234
    v_lshl_add_u32 v241, v234, 4, v233
    v_accvgpr_write_b32 a66, v240
    v_accvgpr_write_b32 a67, v241
    s_mov_b32 s31, 0
    s_mov_b32 s58, 0
    s_waitcnt lgkmcnt(0)
    s_lshl_b32 s76, s80, 16
    s_and_b32 s77, s80, 0xffff0000
    s_lshl_b32 s78, s81, 16
    s_and_b32 s79, s81, 0xffff0000
    s_mov_b32 s67, s82
    s_mov_b32 s68, s83
    s_lshl_b32 s80, s67, 16
    s_and_b32 s81, s67, 0xffff0000
    s_lshl_b32 s82, s68, 16
    s_and_b32 s83, s68, 0xffff0000
    s_lshl_b32 s84, s88, 16
    s_and_b32 s85, s88, 0xffff0000
    s_lshl_b32 s86, s89, 16
    s_and_b32 s87, s89, 0xffff0000
    s_mov_b32 s67, s90
    s_mov_b32 s68, s91
    s_lshl_b32 s88, s67, 16
    s_and_b32 s89, s67, 0xffff0000
    s_lshl_b32 s90, s68, 16
    s_and_b32 s91, s68, 0xffff0000
    s_add_u32 s30, s30, 1
    s_waitcnt vmcnt(12)
    v_lshlrev_b32 v200, 16, v248
    v_and_b32 v201, 0xffff0000, v248
    v_lshlrev_b32 v202, 16, v249
    v_and_b32 v203, 0xffff0000, v249
    v_lshlrev_b32 v204, 16, v250
    v_and_b32 v205, 0xffff0000, v250
    v_lshlrev_b32 v206, 16, v251
    v_and_b32 v207, 0xffff0000, v251
    v_lshlrev_b32 v208, 16, v252
    v_and_b32 v209, 0xffff0000, v252
    v_lshlrev_b32 v210, 16, v253
    v_and_b32 v211, 0xffff0000, v253
    v_lshlrev_b32 v212, 16, v254
    v_and_b32 v213, 0xffff0000, v254
    v_lshlrev_b32 v214, 16, v255
    v_and_b32 v215, 0xffff0000, v255
L_layer:
    v_readfirstlane_b32 s67, v200
    s_nop 1
    v_subrev_f32 v216, s67, v200
    v_subrev_f32 v217, s67, v201
    v_subrev_f32 v218, s67, v202
    v_subrev_f32 v219, s67, v203
    v_subrev_f32 v220, s67, v204
    v_subrev_f32 v221, s67, v205
    v_subrev_f32 v222, s67, v206
    v_subrev_f32 v223, s67, v207
    v_subrev_f32 v224, s67, v208
    v_subrev_f32 v225, s67, v209
    v_subrev_f32 v226, s67, v210
    v_subrev_f32 v227, s67, v211
    v_subrev_f32 v228, s67, v212
    v_subrev_f32 v229, s67, v213
    v_subrev_f32 v230, s67, v214
    v_subrev_f32 v231, s67, v215
    v_add_f32 v232, v216, v217
    v_mul_f32 v233, v216, v216
    v_mul_f32 v235, v217, v217
    v_add_f32 v234, v218, v219
    v_fmac_f32 v233, v218, v218
    v_fmac_f32 v235, v219, v219
    v_fmac_f32 v233, v220, v220
    v_add_f32 v232, v232, v220
    v_fmac_f32 v235, v221, v221
    v_add_f32 v234, v234, v221
    v_fmac_f32 v233, v222, v222
    v_add_f32 v232, v232, v222
    v_fmac_f32 v235, v223, v223
    v_add_f32 v234, v234, v223
    v_fmac_f32 v233, v224, v224
    v_add_f32 v232, v232, v224
    v_fmac_f32 v235, v225, v225
    v_add_f32 v234, v234, v225
    v_fmac_f32 v233, v226, v226
    v_add_f32 v232, v232, v226
    v_fmac_f32 v235, v227, v227
    v_add_f32 v234, v234, v227
    v_fmac_f32 v233, v228, v228
    v_add_f32 v232, v232, v228
    v_fmac_f32 v235, v229, v229
    v_add_f32 v234, v234, v229
    v_fmac_f32 v233, v230, v230
    v_add_f32 v232, v232, v230
    v_fmac_f32 v235, v231, v231
    v_add_f32 v234, v234, v231
    v_add_f32 v232, v232, v234
    v_add_f32 v233, v233, v235
    s_nop 0
    v_add_f32_dpp v232, v232, v232 row_shr:1 row_mask:0xf bank_mask:0xf bound_ctrl:0
    v_add_f32_dpp v233, v233, v233 row_shr:1 row_mask:0xf bank_mask:0xf bound_ctrl:0
    s_nop 0
    v_add_f32_dpp v232, v232, v232 row_shr:2 row_mask:0xf bank_mask:0xf bound_ctrl:0
    v_add_f32_dpp v233, v233, v233 row_shr:2 row_mask:0xf bank_mask:0xf bound_ctrl:0
    s_nop 0
    v_add_f32_dpp v232, v232, v232 row_shr:4 row_mask:0xf bank_mask:0xf bound_ctrl:0
    v_add_f32_dpp v233, v233, v233 row_shr:4 row_mask:0xf bank_mask:0xf bound_ctrl:0
    s_nop 0
    v_add_f32_dpp v232, v232, v232 row_shr:8 row_mask:0xf bank_mask:0xf bound_ctrl:0
    v_add_f32_dpp v233, v233, v233 row_shr:8 row_mask:0xf bank_mask:0xf bound_ctrl:0
    s_nop 0
    v_add_f32_dpp v232, v232, v232 row_bcast:15 row_mask:0xa bank_mask:0xf
    v_add_f32_dpp v233, v233, v233 row_bcast:15 row_mask:0xa bank_mask:0xf
    s_nop 0
    v_add_f32_dpp v232, v232, v232 row_bcast:31 row_mask:0xc bank_mask:0xf
    v_add_f32_dpp v233, v233, v233 row_bcast:31 row_mask:0xc bank_mask:0xf
    v_readlane_b32 s68, v232, 63
    v_readlane_b32 s69, v233, 63
    v_mov_b32 v237, s30
    v_mov_b32 v239, s30
    v_mov_b32 v232, 0x3a800000
    v_mul_f32 v232, s68, v232
    v_add_f32 v236, s67, v232
    v_mul_f32 v233, s68, v232
    v_sub_f32 v238, s69, v233
    v_mov_b32 v237, v238
    s_lshl_b32 s67, s3, 3
    s_add_u32 s67, s67, 155648
    v_mov_b32 v232, s67
    ds_write_b64 v232, v[236:237]
    v_and_b32 v233, 3, v1
    v_lshlrev_b32 v233, 3, v233
    v_add_u32 v233, 155648, v233
    v_and_b32 v247, 31, v1
    v_lshlrev_b32 v246, 7, v247
    v_lshlrev_b32 v247, 4, v247
    s_and_b32 s75, s2, 7
    s_lshl_b32 s75, s75, 11
    s_lshl_b32 s74, s31, 14
    s_add_u32 s75, s75, s74
    s_add_u32 s75, s75, 8388608
    s_lshr_b32 s68, s2, 3
    s_lshl_b32 s68, s68, 4
    s_add_u32 s69, s75, s68
    s_sub_u32 s1, s75, 8388608
    s_lshl_b32 s1, s1, 1
    s_add_u32 s1, s1, 9043968
    s_lshl_b32 s68, s68, 3
    s_add_u32 s70, s1, s68
    s_waitcnt vmcnt(10) lgkmcnt(0)
    s_barrier
    s_cmp_gt_u32 s3, 1
    s_cbranch_scc1 L_st_nopub
    ds_read_b64 v[236:237], v233
    s_waitcnt lgkmcnt(0)
    v_readfirstlane_b32 s67, v236
    s_nop 1
    v_subrev_f32 v232, s67, v236
    v_mul_f32 v233, v232, v232
    s_nop 0
    v_add_f32_dpp v232, v232, v232 quad_perm:[1,0,3,2] row_mask:0xf bank_mask:0xf
    v_add_f32_dpp v237, v237, v237 quad_perm:[1,0,3,2] row_mask:0xf bank_mask:0xf
    v_add_f32_dpp v233, v233, v233 quad_perm:[1,0,3,2] row_mask:0xf bank_mask:0xf
    v_add_f32_dpp v232, v232, v232 quad_perm:[2,3,0,1] row_mask:0xf bank_mask:0xf
    v_add_f32_dpp v237, v237, v237 quad_perm:[2,3,0,1] row_mask:0xf bank_mask:0xf
    v_add_f32_dpp v233, v233, v233 quad_perm:[2,3,0,1] row_mask:0xf bank_mask:0xf
    v_mul_f32 v234, 0x3e800000, v232
    v_add_f32 v236, s67, v234
    v_fma_f32 v233, -v232, v234, v233
    v_fmac_f32 v237, 0x44800000, v233
    v_mov_b32 v238, v237
    v_mov_b32 v237, s30
    v_mov_b32 v239, s30
    v_mov_b32 v232, 0
    s_mov_b64 exec, 1
    s_cmp_lg_u32 s3, 0
    s_cbranch_scc1 L_st_pubB
    buffer_store_dwordx4 v[236:239], v232, s[16:19], s69 offen
    s_branch L_st_pubE
L_st_pubB:
    buffer_store_dwordx4 v[236:239], v232, s[16:19], s70 offen sc1
L_st_pubE:
    s_mov_b64 exec, -1
L_st_nopub:
    s_cmp_lg_u32 s3, 0
    s_cbranch_scc1 L_st_other
    s_mov_b32 s73, 0
    s_mov_b32 s71, 7
L_pstat:
    buffer_load_dwordx4 v[240:243], v247, s[16:19], s75 offen sc1
    s_waitcnt vmcnt(0)
    v_cmp_ne_u32 vcc, s30, v241
    v_cmp_ne_u32_e64 s[52:53], s30, v243
    s_nop 0
    s_or_b64 vcc, vcc, s[52:53]
    s_cmp_eq_u64 vcc, 0
    s_cbranch_scc1 L_pstat_done
    s_sleep 0
    s_add_u32 s73, s73, 1
    s_and_b32 s67, s73, s71
    s_cmp_lg_u32 s67, 0
    s_cbranch_scc1 L_pstat
    buffer_load_dwordx4 v[240:243], v246, s[16:19], s1 offen sc1
    s_waitcnt vmcnt(0)
    v_cmp_ne_u32 vcc, s30, v241
    v_cmp_ne_u32_e64 s[52:53], s30, v243
    s_nop 0
    s_or_b64 vcc, vcc, s[52:53]
    s_cmp_eq_u64 vcc, 0
    s_cbranch_scc1 L_pstat_done
    s_cmp_lt_u32 s73, 0x100000
    s_cbranch_scc1 L_pstat
L_pstat_done:
    s_lshl_b32 s67, s31, 8
    s_add_u32 s67, s67, s2
    s_cmp_ge_u32 s67, 32
    s_cbranch_scc1 L_nogf
    s_lshl_b32 s67, s31, 1
    s_add_u32 s67, s67, s24
    s_lshl_b32 s67, s67, 13
    s_lshl_b32 s68, s25, 9
    s_add_u32 s67, s67, s68
    s_lshl_b32 s68, s26, 7
    s_add_u32 s67, s67, s68
    s_add_u32 s67, s67, 9437184
    v_lshlrev_b32 v234, 11, v1
    v_mov_b32 v235, s30
    s_mov_b64 exec, 15
    buffer_store_dword v235, v234, s[16:19], s67 offen sc1
    s_mov_b64 exec, -1
L_nogf:
    v_readfirstlane_b32 s67, v240
    s_nop 1
    v_subrev_f32 v232, s67, v240
    v_mul_f32 v233, v232, v232
    s_nop 0
    v_add_f32_dpp v232, v232, v232 row_shr:1 row_mask:0xf bank_mask:0xf bound_ctrl:0
    v_add_f32_dpp v233, v233, v233 row_shr:1 row_mask:0xf bank_mask:0xf bound_ctrl:0
    v_add_f32_dpp v242, v242, v242 row_shr:1 row_mask:0xf bank_mask:0xf bound_ctrl:0
    v_add_f32_dpp v232, v232, v232 row_shr:2 row_mask:0xf bank_mask:0xf bound_ctrl:0
    v_add_f32_dpp v233, v233, v233 row_shr:2 row_mask:0xf bank_mask:0xf bound_ctrl:0
    v_add_f32_dpp v242, v242, v242 row_shr:2 row_mask:0xf bank_mask:0xf bound_ctrl:0
    v_add_f32_dpp v232, v232, v232 row_shr:4 row_mask:0xf bank_mask:0xf bound_ctrl:0
    v_add_f32_dpp v233, v233, v233 row_shr:4 row_mask:0xf bank_mask:0xf bound_ctrl:0
    v_add_f32_dpp v242, v242, v242 row_shr:4 row_mask:0xf bank_mask:0xf bound_ctrl:0
    v_add_f32_dpp v232, v232, v232 row_shr:8 row_mask:0xf bank_mask:0xf bound_ctrl:0
    v_add_f32_dpp v233, v233, v233 row_shr:8 row_mask:0xf bank_mask:0xf bound_ctrl:0
    v_add_f32_dpp v242, v242, v242 row_shr:8 row_mask:0xf bank_mask:0xf bound_ctrl:0
    v_add_f32_dpp v232, v232, v232 row_bcast:15 row_mask:0xa bank_mask:0xf
    v_add_f32_dpp v233, v233, v233 row_bcast:15 row_mask:0xa bank_mask:0xf
    v_add_f32_dpp v242, v242, v242 row_bcast:15 row_mask:0xa bank_mask:0xf
    v_readlane_b32 s68, v232, 31
    v_readlane_b32 s69, v233, 31
    v_readlane_b32 s70, v242, 31
    v_mov_b32 v240, 0x3d000000
    v_mul_f32 v240, s68, v240
    v_add_f32 v232, s67, v240
    v_mul_f32 v241, s68, v240
    v_sub_f32 v241, s69, v241
    v_mov_b32 v242, s70
    v_fmac_f32 v242, 0x45800000, v241
    v_mov_b32 v243, 0x3727c5ac
    v_fmac_f32 v243, 0x37000000, v242
    v_rsq_f32 v233, v243
    v_mov_b32 v234, 155712
    ds_write_b64 v234, v[232:233]
    s_waitcnt lgkmcnt(0)
    s_branch L_st_join
L_st_other:
    s_cmp_lg_u32 s31, 0
    s_cbranch_scc1 L_st_join
    s_cmp_lt_u32 s3, 2
    s_cbranch_scc1 L_st_join
    s_mov_b32 s6, 4726784
    s_add_u32 s74, s35, 2097152
    s_sub_u32 s73, s74, 32768
    buffer_store_dwordx4 v[104:107], v244, s[16:19], s74 offen sc1
    buffer_store_dwordx4 v[104:107], v244, s[16:19], s74 offen offset:256 sc1
    buffer_store_dwordx4 v[104:107], v244, s[16:19], s73 offen sc1
    buffer_store_dwordx4 v[104:107], v244, s[16:19], s73 offen offset:256 sc1
    s_add_u32 s59, s63, 0
    s_add_u32 m0, s61, 0
    s_nop 0
    buffer_load_dwordx4 v2, s[4:7], s59 offen offset:0 lds
    buffer_load_dwordx4 v16, s[4:7], s59 offen offset:1024 lds
    buffer_load_dwordx4 v17, s[4:7], s59 offen offset:2048 lds
    buffer_load_dwordx4 v18, s[4:7], s59 offen offset:3072 lds
    s_add_u32 m0, s61, 4096
    s_nop 0
    buffer_load_dwordx4 v19, s[4:7], s59 offen offset:0 lds
    buffer_load_dwordx4 v20, s[4:7], s59 offen offset:1024 lds
    buffer_load_dwordx4 v21, s[4:7], s59 offen offset:2048 lds
    buffer_load_dwordx4 v22, s[4:7], s59 offen offset:3072 lds
    s_add_u32 m0, s61, 8192
    s_nop 0
    buffer_load_dwordx4 v23, s[4:7], s59 offen offset:0 lds
    s_add_u32 s59, s63, 147456
    s_add_u32 m0, s61, 36864
    s_nop 0
    buffer_load_dwordx4 v2, s[4:7], s59 offen offset:0 lds
    buffer_load_dwordx4 v16, s[4:7], s59 offen offset:1024 lds
    buffer_load_dwordx4 v17, s[4:7], s59 offen offset:2048 lds
    buffer_load_dwordx4 v18, s[4:7], s59 offen offset:3072 lds
    s_add_u32 m0, s61, 40960
    s_nop 0
    buffer_load_dwordx4 v19, s[4:7], s59 offen offset:0 lds
    buffer_load_dwordx4 v20, s[4:7], s59 offen offset:1024 lds
    buffer_load_dwordx4 v21, s[4:7], s59 offen offset:2048 lds
    buffer_load_dwordx4 v22, s[4:7], s59 offen offset:3072 lds
    s_add_u32 m0, s61, 45056
    s_nop 0
    buffer_load_dwordx4 v23, s[4:7], s59 offen offset:0 lds
    s_sub_u32 s72, s63, 1152
    s_sub_u32 s61, s61, 18432
    s_add_u32 s59, s72, 0
    s_add_u32 m0, s61, 0
    s_nop 0
    buffer_load_dwordx4 v2, s[4:7], s59 offen offset:0 lds
    buffer_load_dwordx4 v16, s[4:7], s59 offen offset:1024 lds
    buffer_load_dwordx4 v17, s[4:7], s59 offen offset:2048 lds
    buffer_load_dwordx4 v18, s[4:7], s59 offen offset:3072 lds
    s_add_u32 m0, s61, 4096
    s_nop 0
    buffer_load_dwordx4 v19, s[4:7], s59 offen offset:0 lds
    buffer_load_dwordx4 v20, s[4:7], s59 offen offset:1024 lds
    buffer_load_dwordx4 v21, s[4:7], s59 offen offset:2048 lds
    buffer_load_dwordx4 v22, s[4:7], s59 offen offset:3072 lds
    s_add_u32 m0, s61, 8192
    s_nop 0
    buffer_load_dwordx4 v23, s[4:7], s59 offen offset:0 lds
    s_add_u32 s59, s72, 147456
    s_add_u32 m0, s61, 36864
    s_nop 0
    buffer_load_dwordx4 v2, s[4:7], s59 offen offset:0 lds
    buffer_load_dwordx4 v16, s[4:7], s59 offen offset:1024 lds
    buffer_load_dwordx4 v17, s[4:7], s59 offen offset:2048 lds
    buffer_load_dwordx4 v18, s[4:7], s59 offen offset:3072 lds
    s_add_u32 m0, s61, 40960
    s_nop 0
    buffer_load_dwordx4 v19, s[4:7], s59 offen offset:0 lds
    buffer_load_dwordx4 v20, s[4:7], s59 offen offset:1024 lds
    buffer_load_dwordx4 v21, s[4:7], s59 offen offset:2048 lds
    buffer_load_dwordx4 v22, s[4:7], s59 offen offset:3072 lds
    s_add_u32 m0, s61, 45056
    s_nop 0
    buffer_load_dwordx4 v23, s[4:7], s59 offen offset:0 lds
    s_add_u32 s61, s61, 18432
    s_waitcnt vmcnt(36)
L_st_join:
    v_mov_b32 v234, 155712
    s_lshl_b32 s72, s31, 21
    s_add_u32 s74, s35, s72
    s_lshl_b32 s71, s24, 20
    s_add_u32 s71, s71, s72
    v_lshrrev_b32 v244, 4, v1
    v_and_b32 v245, 15, v1
    v_lshlrev_b32 v244, 9, v244
    v_lshl_add_u32 v244, v245, 4, v244
    s_barrier
    ds_read_b64 v[232:233], v234
    s_waitcnt lgkmcnt(0)
    v_mul_f32 v112, s76, v233
    v_mul_f32 v114, s77, v233
    v_mul_f32 v116, s78, v233
    v_mul_f32 v118, s79, v233
    v_mul_f32 v120, s80, v233
    v_mul_f32 v122, s81, v233
    v_mul_f32 v124, s82, v233
    v_mul_f32 v126, s83, v233
    v_mov_b32 v128, s84
    v_mov_b32 v130, s85
    v_mov_b32 v132, s86
    v_mov_b32 v134, s87
    v_mov_b32 v136, s88
    v_mov_b32 v138, s89
    v_mov_b32 v140, s90
    v_mov_b32 v142, s91
    v_fma_f32 v128, -v232, v112, v128
    v_fma_f32 v130, -v232, v114, v130
    v_fma_f32 v132, -v232, v116, v132
    v_fma_f32 v134, -v232, v118, v134
    v_fma_f32 v136, -v232, v120, v136
    v_fma_f32 v138, -v232, v122, v138
    v_fma_f32 v140, -v232, v124, v140
    v_fma_f32 v142, -v232, v126, v142
    v_pk_fma_f32 v[144:145], v[200:201], v[112:113], v[128:129] op_sel_hi:[1,0,0]
    v_pk_fma_f32 v[146:147], v[202:203], v[114:115], v[130:131] op_sel_hi:[1,0,0]
    v_pk_fma_f32 v[148:149], v[204:205], v[116:117], v[132:133] op_sel_hi:[1,0,0]
    v_pk_fma_f32 v[150:151], v[206:207], v[118:119], v[134:135] op_sel_hi:[1,0,0]
    v_pk_fma_f32 v[152:153], v[208:209], v[120:121], v[136:137] op_sel_hi:[1,0,0]
    v_pk_fma_f32 v[154:155], v[210:211], v[122:123], v[138:139] op_sel_hi:[1,0,0]
    v_pk_fma_f32 v[156:157], v[212:213], v[124:125], v[140:141] op_sel_hi:[1,0,0]
    v_pk_fma_f32 v[158:159], v[214:215], v[126:127], v[142:143] op_sel_hi:[1,0,0]
    v_mov_b32 v234, 0xbfb8aa3b
    v_pk_mul_f32 v[160:161], v[144:145], v[234:235] op_sel_hi:[1,0]
    v_pk_mul_f32 v[162:163], v[146:147], v[234:235] op_sel_hi:[1,0]
    v_pk_mul_f32 v[164:165], v[148:149], v[234:235] op_sel_hi:[1,0]
    v_pk_mul_f32 v[166:167], v[150:151], v[234:235] op_sel_hi:[1,0]
    v_pk_mul_f32 v[168:169], v[152:153], v[234:235] op_sel_hi:[1,0]
    v_pk_mul_f32 v[170:171], v[154:155], v[234:235] op_sel_hi:[1,0]
    v_pk_mul_f32 v[172:173], v[156:157], v[234:235] op_sel_hi:[1,0]
    v_pk_mul_f32 v[174:175], v[158:159], v[234:235] op_sel_hi:[1,0]
    v_exp_f32 v160, v160
    v_exp_f32 v161, v161
    v_exp_f32 v162, v162
    v_exp_f32 v163, v163
    v_exp_f32 v164, v164
    v_exp_f32 v165, v165
    v_exp_f32 v166, v166
    v_exp_f32 v167, v167
    v_exp_f32 v168, v168
    v_exp_f32 v169, v169
    v_exp_f32 v170, v170
    v_exp_f32 v171, v171
    v_exp_f32 v172, v172
    v_exp_f32 v173, v173
    v_exp_f32 v174, v174
    v_exp_f32 v175, v175
    v_pk_add_f32 v[160:161], v[160:161], 1.0 op_sel_hi:[1,0]
    v_pk_add_f32 v[162:163], v[162:163], 1.0 op_sel_hi:[1,0]
    v_pk_add_f32 v[164:165], v[164:165], 1.0 op_sel_hi:[1,0]
    v_pk_add_f32 v[166:167], v[166:167], 1.0 op_sel_hi:[1,0]
    v_pk_add_f32 v[168:169], v[168:169], 1.0 op_sel_hi:[1,0]
    v_pk_add_f32 v[170:171], v[170:171], 1.0 op_sel_hi:[1,0]
    v_pk_add_f32 v[172:173], v[172:173], 1.0 op_sel_hi:[1,0]
    v_pk_add_f32 v[174:175], v[174:175], 1.0 op_sel_hi:[1,0]
    v_rcp_f32 v160, v160
    v_rcp_f32 v161, v161
    v_rcp_f32 v162, v162
    v_rcp_f32 v163, v163
    v_rcp_f32 v164, v164
    v_rcp_f32 v165, v165
    v_rcp_f32 v166, v166
    v_rcp_f32 v167, v167
    v_rcp_f32 v168, v168
    v_rcp_f32 v169, v169
    v_rcp_f32 v170, v170
    v_rcp_f32 v171, v171
    v_rcp_f32 v172, v172
    v_rcp_f32 v173, v173
    v_rcp_f32 v174, v174
    v_rcp_f32 v175, v175
    v_pk_mul_f32 v[144:145], v[144:145], v[160:161]
    v_pk_mul_f32 v[146:147], v[146:147], v[162:163]
    v_pk_mul_f32 v[148:149], v[148:149], v[164:165]
    v_pk_mul_f32 v[150:151], v[150:151], v[166:167]
    v_pk_mul_f32 v[152:153], v[152:153], v[168:169]
    v_pk_mul_f32 v[154:155], v[154:155], v[170:171]
    v_pk_mul_f32 v[156:157], v[156:157], v[172:173]
    v_pk_mul_f32 v[158:159], v[158:159], v[174:175]
    v_cvt_pk_bf16_f32 v104, v144, v146
    v_cvt_pk_bf16_f32 v105, v148, v150
    v_cvt_pk_bf16_f32 v106, v152, v154
    v_cvt_pk_bf16_f32 v107, v156, v158
    v_cvt_pk_bf16_f32 v108, v145, v147
    v_cvt_pk_bf16_f32 v109, v149, v151
    v_cvt_pk_bf16_f32 v110, v153, v155
    v_cvt_pk_bf16_f32 v111, v157, v159
    buffer_store_dwordx4 v[104:107], v244, s[16:19], s74 offen sc1
    buffer_store_dwordx4 v[108:111], v244, s[16:19], s74 offen offset:256 sc1
    s_add_u32 s8, s54, s71
    s_addc_u32 s9, s55, 0
    s_mov_b32 s10, 1048576
    s_mov_b32 s11, 0x00020000
    v_accvgpr_write_b32 a0, 0
    v_accvgpr_write_b32 a1, 0
    v_accvgpr_write_b32 a2, 0
    v_accvgpr_write_b32 a3, 0
    v_accvgpr_write_b32 a4, 0
    v_accvgpr_write_b32 a5, 0
    v_accvgpr_write_b32 a6, 0
    v_accvgpr_write_b32 a7, 0
    v_accvgpr_write_b32 a8, 0
    v_accvgpr_write_b32 a9, 0
    v_accvgpr_write_b32 a10, 0
    v_accvgpr_write_b32 a11, 0
    v_accvgpr_write_b32 a12, 0
    v_accvgpr_write_b32 a13, 0
    v_accvgpr_write_b32 a14, 0
    v_accvgpr_write_b32 a15, 0
    v_accvgpr_write_b32 a16, 0
    v_accvgpr_write_b32 a17, 0
    v_accvgpr_write_b32 a18, 0
    v_accvgpr_write_b32 a19, 0
    v_accvgpr_write_b32 a20, 0
    v_accvgpr_write_b32 a21, 0
    v_accvgpr_write_b32 a22, 0
    v_accvgpr_write_b32 a23, 0
    v_accvgpr_write_b32 a24, 0
    v_accvgpr_write_b32 a25, 0
    v_accvgpr_write_b32 a26, 0
    v_accvgpr_write_b32 a27, 0
    v_accvgpr_write_b32 a28, 0
    v_accvgpr_write_b32 a29, 0
    v_accvgpr_write_b32 a30, 0
    v_accvgpr_write_b32 a31, 0
    v_accvgpr_write_b32 a32, 0
    v_accvgpr_write_b32 a33, 0
    v_accvgpr_write_b32 a34, 0
    v_accvgpr_write_b32 a35, 0
    v_accvgpr_write_b32 a36, 0
    v_accvgpr_write_b32 a37, 0
    v_accvgpr_write_b32 a38, 0
    v_accvgpr_write_b32 a39, 0
    v_accvgpr_write_b32 a40, 0
    v_accvgpr_write_b32 a41, 0
    v_accvgpr_write_b32 a42, 0
    v_accvgpr_write_b32 a43, 0
    v_accvgpr_write_b32 a44, 0
    v_accvgpr_write_b32 a45, 0
    v_accvgpr_write_b32 a46, 0
    v_accvgpr_write_b32 a47, 0
    v_accvgpr_write_b32 a48, 0
    v_accvgpr_write_b32 a49, 0
    v_accvgpr_write_b32 a50, 0
    v_accvgpr_write_b32 a51, 0
    v_accvgpr_write_b32 a52, 0
    v_accvgpr_write_b32 a53, 0
    v_accvgpr_write_b32 a54, 0
    v_accvgpr_write_b32 a55, 0
    v_accvgpr_write_b32 a56, 0
    v_accvgpr_write_b32 a57, 0
    v_accvgpr_write_b32 a58, 0
    v_accvgpr_write_b32 a59, 0
    v_accvgpr_write_b32 a60, 0
    v_accvgpr_write_b32 a61, 0
    v_accvgpr_write_b32 a62, 0
    v_accvgpr_write_b32 a63, 0
    s_lshl_b32 s67, s31, 2
    s_add_u32 s67, s67, s3
    s_cmp_lg_u32 s67, 1
    s_cbranch_scc1 L_nopall
    s_lshl_b32 s75, s31, 1
    s_add_u32 s75, s75, s24
    s_lshl_b32 s75, s75, 13
    s_lshl_b32 s68, s25, 11
    s_add_u32 s75, s75, s68
    s_add_u32 s75, s75, 9437184
    v_and_b32 v245, 15, v1
    v_lshlrev_b32 v245, 7, v245
    s_mov_b32 s73, 0
L_pgf:
    buffer_load_dword v240, v245, s[16:19], s75 offen sc1
    s_waitcnt vmcnt(0)
    v_cmp_eq_u32 vcc, s30, v240
    s_add_u32 s73, s73, 1
    s_lshr_b32 s67, vcc_lo, 1
    s_or_b32 s67, s67, vcc_lo
    s_lshr_b32 s68, s67, 2
    s_or_b32 s67, s67, s68
    s_and_b32 s67, s67, 0x1111
    s_cmp_eq_u32 s67, 0x1111
    s_cbranch_scc1 L_nopall
    s_cmp_lt_u32 s73, 0x40000
    s_cbranch_scc1 L_pgf
L_nopall:
    s_waitcnt vmcnt(0)
    s_barrier
    s_mov_b32 s60, 0
    s_mov_b32 s10, 1048576
    buffer_load_dwordx4 v[104:107], v12, s[8:11], s60 offen offset:0 sc1
    buffer_load_dwordx4 v[108:111], v12, s[8:11], s60 offen offset:256 sc1
    buffer_load_dwordx4 v[112:115], v11, s[8:11], s60 offen offset:0 sc1
    buffer_load_dwordx4 v[116:119], v11, s[8:11], s60 offen offset:256 sc1
    buffer_load_dwordx4 v[120:123], v11, s[8:11], s60 offen offset:512 sc1
    buffer_load_dwordx4 v[124:127], v11, s[8:11], s60 offen offset:768 sc1
    buffer_load_dwordx4 v[128:131], v11, s[8:11], s60 offen offset:1024 sc1
    buffer_load_dwordx4 v[132:135], v11, s[8:11], s60 offen offset:1280 sc1
    buffer_load_dwordx4 v[136:139], v11, s[8:11], s60 offen offset:1536 sc1
    buffer_load_dwordx4 v[140:143], v11, s[8:11], s60 offen offset:1792 sc1
    buffer_load_dwordx4 v[144:147], v13, s[8:11], s60 offen offset:0 sc1
    buffer_load_dwordx4 v[148:151], v13, s[8:11], s60 offen offset:256 sc1
    s_mov_b32 s60, 262144
    s_cmp_lg_u32 s31, 0
    s_cbranch_scc1 L_l1wait
    s_lshl_b32 s67, s3, 3
    s_add_u32 s67, s67, s28
    s_lshl_b32 s67, s67, 1
    s_add_u32 s68, s44, s67
    s_addc_u32 s69, s45, 0
    s_add_u32 s70, s46, s67
    s_addc_u32 s71, s47, 0
    s_load_dwordx4 s[80:83], s[68:69], 0
    s_load_dwordx4 s[88:91], s[70:71], 0
    s_mov_b32 s6, 4726784
    s_mov_b32 s4, s40
    s_mov_b32 s5, s41
    s_mov_b32 s6, 4726784
    s_lshl_b32 s67, s27, 2
    s_add_u32 s67, s67, s3
    s_add_u32 s67, s67, s28
    s_mul_i32 s67, s67, 9216
    s_add_u32 s67, s67, 11264
    v_lshlrev_b32 v246, 4, v1
    s_mov_b32 m0, 147456
    s_nop 0
    buffer_load_dwordx4 v246, s[4:7], s67 offen offset:0 lds
    buffer_load_dwordx4 v246, s[4:7], s67 offen offset:1024 lds
    v_lshlrev_b32 v48, 16, v40
    v_and_b32 v49, 0xffff0000, v40
    v_lshlrev_b32 v50, 16, v41
    v_and_b32 v51, 0xffff0000, v41
    v_lshlrev_b32 v52, 16, v42
    v_and_b32 v53, 0xffff0000, v42
    v_mul_f32 v56, 0xbfb8aa3b, v48
    v_mul_f32 v57, 0xbfb8aa3b, v49
    v_mul_f32 v58, 0xbfb8aa3b, v50
    v_mul_f32 v59, 0xbfb8aa3b, v51
    v_mul_f32 v60, 0xbfb8aa3b, v52
    v_mul_f32 v61, 0xbfb8aa3b, v53
    v_exp_f32 v56, v56
    v_exp_f32 v57, v57
    v_exp_f32 v58, v58
    v_exp_f32 v59, v59
    v_exp_f32 v60, v60
    v_exp_f32 v61, v61
    v_add_f32 v56, 1.0, v56
    v_add_f32 v57, 1.0, v57
    v_add_f32 v58, 1.0, v58
    v_add_f32 v59, 1.0, v59
    v_add_f32 v60, 1.0, v60
    v_add_f32 v61, 1.0, v61
    v_rcp_f32 v56, v56
    v_rcp_f32 v57, v57
    v_rcp_f32 v58, v58
    v_rcp_f32 v59, v59
    v_rcp_f32 v60, v60
    v_rcp_f32 v61, v61
    v_mul_f32 v48, v48, v56
    v_mul_f32 v49, v49, v57
    v_mul_f32 v50, v50, v58
    v_mul_f32 v51, v51, v59
    v_mul_f32 v52, v52, v60
    v_mul_f32 v53, v53, v61
    v_lshlrev_b32 v68, 16, v32
    v_and_b32 v69, 0xffff0000, v32
    v_mul_f32 v64, v68, v48
    v_mul_f32 v66, v69, v48
    v_lshlrev_b32 v68, 16, v33
    v_and_b32 v69, 0xffff0000, v33
    v_fmac_f32 v64, v68, v49
    v_fmac_f32 v66, v69, v49
    v_lshlrev_b32 v68, 16, v34
    v_and_b32 v69, 0xffff0000, v34
    v_fmac_f32 v64, v68, v50
    v_fmac_f32 v66, v69, v50
    v_lshlrev_b32 v68, 16, v35
    v_and_b32 v69, 0xffff0000, v35
    v_fmac_f32 v64, v68, v51
    v_fmac_f32 v66, v69, v51
    v_lshlrev_b32 v68, 16, v36
    v_and_b32 v69, 0xffff0000, v36
    v_fmac_f32 v64, v68, v52
    v_fmac_f32 v66, v69, v52
    v_lshlrev_b32 v68, 16, v37
    v_and_b32 v69, 0xffff0000, v37
    v_fmac_f32 v64, v68, v53
    v_fmac_f32 v66, v69, v53
    v_mov_b32 v68, v64
    v_mov_b32 v69, v66
    s_nop 0
    v_permlane32_swap_b32 v68, v64
    v_permlane32_swap_b32 v69, v66
    v_add_f32 v64, v64, v68
    v_add_f32 v66, v66, v69
    v_mov_b32 v68, v64
    v_mov_b32 v69, v66
    s_nop 0
    v_permlane16_swap_b32 v68, v64
    v_permlane16_swap_b32 v69, v66
    v_add_f32 v64, v64, v68
    v_add_f32 v66, v66, v69
    v_mov_b32 v65, s30
    v_mov_b32 v67, s30
    s_lshl_b32 s67, s24, 4
    s_lshr_b32 s68, s28, 5
    s_add_u32 s67, s67, s68
    s_lshl_b32 s67, s67, 13
    s_lshl_b32 s68, s27, 2
    s_add_u32 s68, s68, s3
    s_lshl_b32 s68, s68, 4
    s_add_u32 s67, s67, s68
    s_add_u32 s67, s67, 8454144
    v_lshlrev_b32 v68, 9, v1
    s_mov_b64 exec, 0xffff
    buffer_store_dwordx4 v[64:67], v68, s[16:19], s67 offen sc1
    s_mov_b64 exec, -1
    ds_read_b128 v[68:71], v3 offset:0
    ds_read_b128 v[72:75], v4 offset:0
    ds_read_b128 v[76:79], v5 offset:0
    ds_read_b128 v[80:83], v6 offset:0
    ds_read_b128 v[84:87], v7 offset:0
    ds_read_b128 v[88:91], v8 offset:0
    ds_read_b128 v[92:95], v9 offset:0
    ds_read_b128 v[96:99], v10 offset:0
    ds_read_b128 v[100:103], v3 offset:1024
    s_waitcnt lgkmcnt(0)
    v_perm_b32 v36, v73, v68, s57
    v_perm_b32 v37, v82, v77, s57
    v_perm_b32 v38, v91, v86, s57
    v_perm_b32 v39, v100, v95, s57
    v_perm_b32 v48, v74, v70, s56
    v_perm_b32 v49, v83, v79, s56
    v_perm_b32 v50, v92, v88, s56
    v_perm_b32 v51, v101, v97, s56
    v_perm_b32 v60, v76, v71, s57
    v_perm_b32 v61, v85, v80, s57
    v_perm_b32 v62, v94, v89, s57
    v_perm_b32 v63, v103, v98, s57
    s_waitcnt lgkmcnt(0)
    s_lshl_b32 s76, s80, 16
    s_and_b32 s77, s80, 0xffff0000
    s_lshl_b32 s78, s81, 16
    s_and_b32 s79, s81, 0xffff0000
    s_mov_b32 s67, s82
    s_mov_b32 s68, s83
    s_lshl_b32 s80, s67, 16
    s_and_b32 s81, s67, 0xffff0000
    s_lshl_b32 s82, s68, 16
    s_and_b32 s83, s68, 0xffff0000
    s_lshl_b32 s84, s88, 16
    s_and_b32 s85, s88, 0xffff0000
    s_lshl_b32 s86, s89, 16
    s_and_b32 s87, s89, 0xffff0000
    s_mov_b32 s67, s90
    s_mov_b32 s68, s91
    s_lshl_b32 s88, s67, 16
    s_and_b32 s89, s67, 0xffff0000
    s_lshl_b32 s90, s68, 16
    s_and_b32 s91, s68, 0xffff0000
    s_lshl_b32 s42, s27, 2
    s_add_u32 s42, s42, s3
    s_add_u32 s42, s42, s28
    s_mul_i32 s42, s42, 9216
    s_add_u32 s42, s42, 4096
    s_add_u32 s12, s40, 9216
    s_addc_u32 s13, s41, 0
    s_mov_b32 s14, 4717568
    s_mov_b32 s43, 4726784
    s_add_u32 s59, s63, 147456
    s_waitcnt vmcnt(3)
    s_branch L_chk
L_l1wait:
    s_mov_b32 s14, 0
    s_mov_b32 s43, 0
    s_waitcnt vmcnt(0)
L_chk:
    s_mov_b32 s72, 0
    s_mov_b32 s73, 0
    s_waitcnt vmcnt(63)
    s_branch L_pact_chk_3
L_pact_1:
    buffer_load_dwordx4 v[104:107], v12, s[8:11], s72 offen offset:0 sc1
    buffer_load_dwordx4 v[108:111], v12, s[8:11], s72 offen offset:256 sc1
    buffer_load_dwordx4 v[112:115], v11, s[8:11], s72 offen offset:0 sc1
    buffer_load_dwordx4 v[116:119], v11, s[8:11], s72 offen offset:256 sc1
    buffer_load_dwordx4 v[120:123], v11, s[8:11], s72 offen offset:512 sc1
    buffer_load_dwordx4 v[124:127], v11, s[8:11], s72 offen offset:768 sc1
    buffer_load_dwordx4 v[128:131], v11, s[8:11], s72 offen offset:1024 sc1
    buffer_load_dwordx4 v[132:135], v11, s[8:11], s72 offen offset:1280 sc1
    buffer_load_dwordx4 v[136:139], v11, s[8:11], s72 offen offset:1536 sc1
    buffer_load_dwordx4 v[140:143], v11, s[8:11], s72 offen offset:1792 sc1
    buffer_load_dwordx4 v[144:147], v13, s[8:11], s72 offen offset:0 sc1
    buffer_load_dwordx4 v[148:151], v13, s[8:11], s72 offen offset:256 sc1
    s_waitcnt vmcnt(0)
L_pact_chk_3:
    v_max3_u32 v0, v104, v108, v112
    v_max3_u32 v0, v0, v116, v120
    v_max3_u32 v0, v0, v124, v128
    v_max3_u32 v0, v0, v132, v136
    v_max3_u32 v0, v0, v140, v144
    v_max_u32 v0, v0, v148
    v_cmp_eq_u32 vcc, -1, v0
    s_add_u32 s73, s73, 1
    s_cmp_eq_u64 vcc, 0
    s_cbranch_scc1 L_pact_ok_2
    s_sleep 4
    s_cmp_lt_u32 s73, 0x8000
    s_cbranch_scc1 L_pact_1
L_pact_ok_2:
L_go:
L_conv_4:
    v_mfma_f32_16x16x32_bf16 a[0:3], v[36:39], v[104:107], a[0:3]
    s_add_u32 s59, s59, 4294822144
    s_add_u32 m0, s61, 73728
    v_mfma_f32_16x16x32_bf16 a[8:11], v[36:39], v[112:115], a[8:11]
    v_perm_b32 v32, v72, v68, s56
    v_perm_b32 v33, v81, v77, s56
    v_mfma_f32_16x16x32_bf16 a[16:19], v[36:39], v[120:123], a[16:19]
    v_perm_b32 v34, v90, v86, s56
    v_perm_b32 v35, v99, v95, s56
    v_mfma_f32_16x16x32_bf16 a[24:27], v[36:39], v[128:131], a[24:27]
    buffer_load_dwordx4 v2, s[4:7], s59 offen offset:0 lds
    v_mfma_f32_16x16x32_bf16 a[4:7], v[36:39], v[108:111], a[4:7]
    v_perm_b32 v44, v74, v69, s57
    v_perm_b32 v45, v83, v78, s57
    v_mfma_f32_16x16x32_bf16 a[12:15], v[36:39], v[116:119], a[12:15]
    v_perm_b32 v46, v92, v87, s57
    v_mov_b32_dpp v200, v108 row_shr:1 row_mask:0xf bank_mask:0xf bound_ctrl:0
    v_mfma_f32_16x16x32_bf16 a[20:23], v[36:39], v[124:127], a[20:23]
    buffer_load_dwordx4 v16, s[4:7], s59 offen offset:1024 lds
    v_mfma_f32_16x16x32_bf16 a[28:31], v[36:39], v[132:135], a[28:31]
    s_mov_b32 s10, 1048576
    v_perm_b32 v47, v101, v96, s57
    v_mfma_f32_16x16x32_bf16 a[0:3], v[48:51], v[112:115], a[0:3]
    v_perm_b32 v56, v75, v71, s56
    v_mov_b32_dpp v201, v109 row_shr:1 row_mask:0xf bank_mask:0xf bound_ctrl:0
    v_mfma_f32_16x16x32_bf16 a[8:11], v[48:51], v[120:123], a[8:11]
    v_perm_b32 v57, v84, v80, s56
    v_mov_b32_dpp v202, v110 row_shr:1 row_mask:0xf bank_mask:0xf bound_ctrl:0
    v_mfma_f32_16x16x32_bf16 a[16:19], v[48:51], v[128:131], a[16:19]
    buffer_load_dwordx4 v[152:155], v12, s[8:11], s60 offen offset:0 sc1
    v_mfma_f32_16x16x32_bf16 a[24:27], v[48:51], v[136:139], a[24:27]
    v_perm_b32 v58, v93, v89, s56
    v_perm_b32 v59, v102, v98, s56
    v_mfma_f32_16x16x32_bf16 a[4:7], v[48:51], v[116:119], a[4:7]
    v_mov_b32_dpp v203, v111 row_shr:1 row_mask:0xf bank_mask:0xf bound_ctrl:0
    v_mov_b32_dpp v204, v116 row_shr:1 row_mask:0xf bank_mask:0xf bound_ctrl:0
    v_mfma_f32_16x16x32_bf16 a[12:15], v[48:51], v[124:127], a[12:15]
    v_mov_b32_dpp v205, v117 row_shr:1 row_mask:0xf bank_mask:0xf bound_ctrl:0
    v_mov_b32_dpp v206, v118 row_shr:1 row_mask:0xf bank_mask:0xf bound_ctrl:0
    v_mfma_f32_16x16x32_bf16 a[20:23], v[48:51], v[132:135], a[20:23]
    buffer_load_dwordx4 v17, s[4:7], s59 offen offset:2048 lds
    v_mfma_f32_16x16x32_bf16 a[28:31], v[48:51], v[140:143], a[28:31]
    v_mov_b32_dpp v207, v119 row_shr:1 row_mask:0xf bank_mask:0xf bound_ctrl:0
    v_mov_b32_dpp v208, v124 row_shr:1 row_mask:0xf bank_mask:0xf bound_ctrl:0
    v_mfma_f32_16x16x32_bf16 a[0:3], v[60:63], v[120:123], a[0:3]
    v_mov_b32_dpp v209, v125 row_shr:1 row_mask:0xf bank_mask:0xf bound_ctrl:0
    v_mov_b32_dpp v210, v126 row_shr:1 row_mask:0xf bank_mask:0xf bound_ctrl:0
    v_mfma_f32_16x16x32_bf16 a[8:11], v[60:63], v[128:131], a[8:11]
    v_mov_b32_dpp v211, v127 row_shr:1 row_mask:0xf bank_mask:0xf bound_ctrl:0
    v_mov_b32_dpp v212, v132 row_shr:1 row_mask:0xf bank_mask:0xf bound_ctrl:0
    v_mfma_f32_16x16x32_bf16 a[16:19], v[60:63], v[136:139], a[16:19]
    buffer_load_dwordx4 v18, s[4:7], s59 offen offset:3072 lds
    v_mfma_f32_16x16x32_bf16 a[24:27], v[60:63], v[144:147], a[24:27]
    v_mov_b32_dpp v213, v133 row_shr:1 row_mask:0xf bank_mask:0xf bound_ctrl:0
    v_mov_b32_dpp v214, v134 row_shr:1 row_mask:0xf bank_mask:0xf bound_ctrl:0
    v_mfma_f32_16x16x32_bf16 a[4:7], v[60:63], v[124:127], a[4:7]
    v_mov_b32_dpp v215, v135 row_shr:1 row_mask:0xf bank_mask:0xf bound_ctrl:0
    v_perm_b32 v40, v73, v69, s56
    v_mfma_f32_16x16x32_bf16 a[12:15], v[60:63], v[132:135], a[12:15]
    v_perm_b32 v41, v82, v78, s56
    v_perm_b32 v42, v91, v87, s56
    v_mfma_f32_16x16x32_bf16 a[20:23], v[60:63], v[140:143], a[20:23]
    buffer_load_dwordx4 v[156:159], v12, s[8:11], s60 offen offset:256 sc1
    v_mfma_f32_16x16x32_bf16 a[28:31], v[60:63], v[148:151], a[28:31]
    s_add_u32 m0, s61, 77824
    v_perm_b32 v43, v100, v96, s56
    v_mfma_f32_16x16x32_bf16 a[4:7], v[32:35], v[104:107], a[4:7]
    v_perm_b32 v52, v75, v70, s57
    v_perm_b32 v53, v84, v79, s57
    v_mfma_f32_16x16x32_bf16 a[12:15], v[32:35], v[112:115], a[12:15]
    v_perm_b32 v54, v93, v88, s57
    v_perm_b32 v55, v102, v97, s57
    v_mfma_f32_16x16x32_bf16 a[20:23], v[32:35], v[120:123], a[20:23]
    buffer_load_dwordx4 v19, s[4:7], s59 offen offset:0 lds
    v_mfma_f32_16x16x32_bf16 a[28:31], v[32:35], v[128:131], a[28:31]
    v_perm_b32 v64, v76, v72, s56
    v_perm_b32 v65, v85, v81, s56
    v_mfma_f32_16x16x32_bf16 a[0:3], v[32:35], v[200:203], a[0:3]
    v_perm_b32 v66, v94, v90, s56
    v_perm_b32 v67, v103, v99, s56
    v_mfma_f32_16x16x32_bf16 a[8:11], v[32:35], v[204:207], a[8:11]
    v_mov_b32_dpp v216, v140 row_shr:1 row_mask:0xf bank_mask:0xf bound_ctrl:0
    v_mov_b32_dpp v217, v141 row_shr:1 row_mask:0xf bank_mask:0xf bound_ctrl:0
    v_mfma_f32_16x16x32_bf16 a[16:19], v[32:35], v[208:211], a[16:19]
    buffer_load_dwordx4 v[160:163], v11, s[8:11], s60 offen offset:0 sc1
    v_mfma_f32_16x16x32_bf16 a[24:27], v[32:35], v[212:215], a[24:27]
    v_mov_b32_dpp v218, v142 row_shr:1 row_mask:0xf bank_mask:0xf bound_ctrl:0
    v_mov_b32_dpp v219, v143 row_shr:1 row_mask:0xf bank_mask:0xf bound_ctrl:0
    v_mfma_f32_16x16x32_bf16 a[4:7], v[44:47], v[112:115], a[4:7]
    v_mov_b32_dpp v220, v148 row_shr:1 row_mask:0xf bank_mask:0xf bound_ctrl:0
    v_mov_b32_dpp v221, v149 row_shr:1 row_mask:0xf bank_mask:0xf bound_ctrl:0
    v_mfma_f32_16x16x32_bf16 a[12:15], v[44:47], v[120:123], a[12:15]
    s_waitcnt vmcnt(12)
    s_barrier
    v_mfma_f32_16x16x32_bf16 a[20:23], v[44:47], v[128:131], a[20:23]
    buffer_load_dwordx4 v20, s[4:7], s59 offen offset:1024 lds
    v_mfma_f32_16x16x32_bf16 a[28:31], v[44:47], v[136:139], a[28:31]
    v_mov_b32_dpp v222, v150 row_shr:1 row_mask:0xf bank_mask:0xf bound_ctrl:0
    v_mov_b32_dpp v223, v151 row_shr:1 row_mask:0xf bank_mask:0xf bound_ctrl:0
    v_mfma_f32_16x16x32_bf16 a[0:3], v[44:47], v[204:207], a[0:3]
    ds_read_b128 v[68:71], v3 offset:36864
    ds_read_b128 v[72:75], v4 offset:36864
    v_mfma_f32_16x16x32_bf16 a[8:11], v[44:47], v[208:211], a[8:11]
    buffer_load_dwordx4 v[164:167], v11, s[8:11], s60 offen offset:256 sc1
    v_mfma_f32_16x16x32_bf16 a[16:19], v[44:47], v[212:215], a[16:19]
    ds_read_b128 v[76:79], v5 offset:36864
    ds_read_b128 v[80:83], v6 offset:36864
    v_mfma_f32_16x16x32_bf16 a[24:27], v[44:47], v[216:219], a[24:27]
    ds_read_b128 v[84:87], v7 offset:36864
    ds_read_b128 v[88:91], v8 offset:36864
    v_mfma_f32_16x16x32_bf16 a[4:7], v[56:59], v[120:123], a[4:7]
    ds_read_b128 v[92:95], v9 offset:36864
    ds_read_b128 v[96:99], v10 offset:36864
    v_mfma_f32_16x16x32_bf16 a[12:15], v[56:59], v[128:131], a[12:15]
    buffer_load_dwordx4 v21, s[4:7], s59 offen offset:2048 lds
    v_mfma_f32_16x16x32_bf16 a[20:23], v[56:59], v[136:139], a[20:23]
    ds_read_b128 v[100:103], v3 offset:37888
    v_mov_b32_dpp v224, v104 row_shl:1 row_mask:0xf bank_mask:0xf bound_ctrl:0
    v_mfma_f32_16x16x32_bf16 a[28:31], v[56:59], v[144:147], a[28:31]
    v_mov_b32_dpp v225, v105 row_shl:1 row_mask:0xf bank_mask:0xf bound_ctrl:0
    v_mov_b32_dpp v226, v106 row_shl:1 row_mask:0xf bank_mask:0xf bound_ctrl:0
    v_mfma_f32_16x16x32_bf16 a[0:3], v[56:59], v[208:211], a[0:3]
    v_mov_b32_dpp v227, v107 row_shl:1 row_mask:0xf bank_mask:0xf bound_ctrl:0
    v_mov_b32_dpp v228, v112 row_shl:1 row_mask:0xf bank_mask:0xf bound_ctrl:0
    v_mfma_f32_16x16x32_bf16 a[8:11], v[56:59], v[212:215], a[8:11]
    buffer_load_dwordx4 v[168:171], v11, s[8:11], s60 offen offset:512 sc1
    v_mfma_f32_16x16x32_bf16 a[16:19], v[56:59], v[216:219], a[16:19]
    v_mov_b32_dpp v229, v113 row_shl:1 row_mask:0xf bank_mask:0xf bound_ctrl:0
    v_mov_b32_dpp v230, v114 row_shl:1 row_mask:0xf bank_mask:0xf bound_ctrl:0
    v_mfma_f32_16x16x32_bf16 a[24:27], v[56:59], v[220:223], a[24:27]
    v_mov_b32_dpp v231, v115 row_shl:1 row_mask:0xf bank_mask:0xf bound_ctrl:0
    v_mov_b32_dpp v232, v120 row_shl:1 row_mask:0xf bank_mask:0xf bound_ctrl:0
    v_mfma_f32_16x16x32_bf16 a[0:3], v[40:43], v[108:111], a[0:3]
    v_mov_b32_dpp v233, v121 row_shl:1 row_mask:0xf bank_mask:0xf bound_ctrl:0
    v_mov_b32_dpp v234, v122 row_shl:1 row_mask:0xf bank_mask:0xf bound_ctrl:0
    v_mov_b32_dpp v235, v123 row_shl:1 row_mask:0xf bank_mask:0xf bound_ctrl:0
    v_mov_b32_dpp v236, v128 row_shl:1 row_mask:0xf bank_mask:0xf bound_ctrl:0
    v_mov_b32_dpp v237, v129 row_shl:1 row_mask:0xf bank_mask:0xf bound_ctrl:0
    v_mov_b32_dpp v238, v130 row_shl:1 row_mask:0xf bank_mask:0xf bound_ctrl:0
    v_mov_b32_dpp v239, v131 row_shl:1 row_mask:0xf bank_mask:0xf bound_ctrl:0
    v_mfma_f32_16x16x32_bf16 a[8:11], v[40:43], v[116:119], a[8:11]
    buffer_load_dwordx4 v22, s[4:7], s59 offen offset:3072 lds
    v_mfma_f32_16x16x32_bf16 a[16:19], v[40:43], v[124:127], a[16:19]
    s_add_u32 m0, s61, 81920
    s_waitcnt lgkmcnt(0)
    v_mfma_f32_16x16x32_bf16 a[24:27], v[40:43], v[132:135], a[24:27]
    v_mov_b32_dpp v240, v136 row_shl:1 row_mask:0xf bank_mask:0xf bound_ctrl:0
    v_mov_b32_dpp v241, v137 row_shl:1 row_mask:0xf bank_mask:0xf bound_ctrl:0
    v_mfma_f32_16x16x32_bf16 a[4:7], v[40:43], v[224:227], a[4:7]
    v_mov_b32_dpp v242, v138 row_shl:1 row_mask:0xf bank_mask:0xf bound_ctrl:0
    v_mov_b32_dpp v243, v139 row_shl:1 row_mask:0xf bank_mask:0xf bound_ctrl:0
    v_mfma_f32_16x16x32_bf16 a[12:15], v[40:43], v[228:231], a[12:15]
    buffer_load_dwordx4 v23, s[4:7], s59 offen offset:0 lds
    v_mfma_f32_16x16x32_bf16 a[20:23], v[40:43], v[232:235], a[20:23]
    v_mov_b32_dpp v244, v144 row_shl:1 row_mask:0xf bank_mask:0xf bound_ctrl:0
    v_mov_b32_dpp v245, v145 row_shl:1 row_mask:0xf bank_mask:0xf bound_ctrl:0
    v_mfma_f32_16x16x32_bf16 a[28:31], v[40:43], v[236:239], a[28:31]
    v_mov_b32_dpp v246, v146 row_shl:1 row_mask:0xf bank_mask:0xf bound_ctrl:0
    v_mov_b32_dpp v247, v147 row_shl:1 row_mask:0xf bank_mask:0xf bound_ctrl:0
    v_mfma_f32_16x16x32_bf16 a[0:3], v[52:55], v[116:119], a[0:3]
    v_perm_b32 v36, v73, v68, s57
    v_perm_b32 v37, v82, v77, s57
    v_mfma_f32_16x16x32_bf16 a[8:11], v[52:55], v[124:127], a[8:11]
    buffer_load_dwordx4 v[172:175], v11, s[8:11], s60 offen offset:768 sc1
    v_mfma_f32_16x16x32_bf16 a[16:19], v[52:55], v[132:135], a[16:19]
    v_perm_b32 v38, v91, v86, s57
    v_perm_b32 v39, v100, v95, s57
    v_mfma_f32_16x16x32_bf16 a[24:27], v[52:55], v[140:143], a[24:27]
    v_perm_b32 v48, v74, v70, s56
    v_perm_b32 v49, v83, v79, s56
    v_mfma_f32_16x16x32_bf16 a[4:7], v[52:55], v[228:231], a[4:7]
    v_perm_b32 v50, v92, v88, s56
    v_perm_b32 v51, v101, v97, s56
    v_mfma_f32_16x16x32_bf16 a[12:15], v[52:55], v[232:235], a[12:15]
    buffer_load_dwordx4 v[176:179], v11, s[8:11], s60 offen offset:1024 sc1
    v_mfma_f32_16x16x32_bf16 a[20:23], v[52:55], v[236:239], a[20:23]
    v_perm_b32 v60, v76, v71, s57
    v_perm_b32 v61, v85, v80, s57
    v_mfma_f32_16x16x32_bf16 a[28:31], v[52:55], v[240:243], a[28:31]
    v_perm_b32 v62, v94, v89, s57
    v_perm_b32 v63, v103, v98, s57
    v_mfma_f32_16x16x32_bf16 a[0:3], v[64:67], v[124:127], a[0:3]
    v_mfma_f32_16x16x32_bf16 a[8:11], v[64:67], v[132:135], a[8:11]
    buffer_load_dwordx4 v[180:183], v11, s[8:11], s60 offen offset:1280 sc1
    v_mfma_f32_16x16x32_bf16 a[16:19], v[64:67], v[140:143], a[16:19]
    s_add_u32 s59, s59, 147456
    s_add_u32 m0, s61, 110592
    v_mfma_f32_16x16x32_bf16 a[24:27], v[64:67], v[148:151], a[24:27]
    v_mfma_f32_16x16x32_bf16 a[4:7], v[64:67], v[232:235], a[4:7]
    v_mfma_f32_16x16x32_bf16 a[12:15], v[64:67], v[236:239], a[12:15]
    v_mfma_f32_16x16x32_bf16 a[20:23], v[64:67], v[240:243], a[20:23]
    v_mfma_f32_16x16x32_bf16 a[28:31], v[64:67], v[244:247], a[28:31]
    v_mfma_f32_16x16x32_bf16 a[32:35], v[36:39], v[104:107], a[32:35]
    v_perm_b32 v32, v72, v68, s56
    v_perm_b32 v33, v81, v77, s56
    v_mfma_f32_16x16x32_bf16 a[40:43], v[36:39], v[112:115], a[40:43]
    v_perm_b32 v34, v90, v86, s56
    v_perm_b32 v35, v99, v95, s56
    v_mfma_f32_16x16x32_bf16 a[48:51], v[36:39], v[120:123], a[48:51]
    v_perm_b32 v44, v74, v69, s57
    v_mfma_f32_16x16x32_bf16 a[56:59], v[36:39], v[128:131], a[56:59]
    buffer_load_dwordx4 v2, s[4:7], s59 offen offset:0 lds
    v_mfma_f32_16x16x32_bf16 a[36:39], v[36:39], v[108:111], a[36:39]
    v_perm_b32 v45, v83, v78, s57
    v_mfma_f32_16x16x32_bf16 a[44:47], v[36:39], v[116:119], a[44:47]
    v_perm_b32 v46, v92, v87, s57
    v_mfma_f32_16x16x32_bf16 a[52:55], v[36:39], v[124:127], a[52:55]
    buffer_load_dwordx4 v[184:187], v11, s[8:11], s60 offen offset:1536 sc1
    v_mfma_f32_16x16x32_bf16 a[60:63], v[36:39], v[132:135], a[60:63]
    v_perm_b32 v47, v101, v96, s57
    v_perm_b32 v56, v75, v71, s56
    v_mfma_f32_16x16x32_bf16 a[32:35], v[48:51], v[112:115], a[32:35]
    v_mfma_f32_16x16x32_bf16 a[40:43], v[48:51], v[120:123], a[40:43]
    v_perm_b32 v57, v84, v80, s56
    v_mfma_f32_16x16x32_bf16 a[48:51], v[48:51], v[128:131], a[48:51]
    buffer_load_dwordx4 v16, s[4:7], s59 offen offset:1024 lds
    v_mfma_f32_16x16x32_bf16 a[56:59], v[48:51], v[136:139], a[56:59]
    v_perm_b32 v58, v93, v89, s56
    v_perm_b32 v59, v102, v98, s56
    v_mfma_f32_16x16x32_bf16 a[36:39], v[48:51], v[116:119], a[36:39]
    v_mfma_f32_16x16x32_bf16 a[44:47], v[48:51], v[124:127], a[44:47]
    v_mfma_f32_16x16x32_bf16 a[52:55], v[48:51], v[132:135], a[52:55]
    buffer_load_dwordx4 v[188:191], v11, s[8:11], s60 offen offset:1792 sc1
    v_mfma_f32_16x16x32_bf16 a[60:63], v[48:51], v[140:143], a[60:63]
    v_perm_b32 v40, v73, v69, s56
    v_perm_b32 v41, v82, v78, s56
    v_mfma_f32_16x16x32_bf16 a[32:35], v[60:63], v[120:123], a[32:35]
    v_perm_b32 v42, v91, v87, s56
    v_perm_b32 v43, v100, v96, s56
    v_mfma_f32_16x16x32_bf16 a[40:43], v[60:63], v[128:131], a[40:43]
    v_perm_b32 v52, v75, v70, s57
    v_mfma_f32_16x16x32_bf16 a[48:51], v[60:63], v[136:139], a[48:51]
    buffer_load_dwordx4 v17, s[4:7], s59 offen offset:2048 lds
    v_mfma_f32_16x16x32_bf16 a[56:59], v[60:63], v[144:147], a[56:59]
    v_perm_b32 v53, v84, v79, s57
    v_perm_b32 v54, v93, v88, s57
    v_mfma_f32_16x16x32_bf16 a[36:39], v[60:63], v[124:127], a[36:39]
    v_perm_b32 v55, v102, v97, s57
    v_mfma_f32_16x16x32_bf16 a[44:47], v[60:63], v[132:135], a[44:47]
    v_mfma_f32_16x16x32_bf16 a[52:55], v[60:63], v[140:143], a[52:55]
    buffer_load_dwordx4 v[192:195], v13, s[8:11], s60 offen offset:0 sc1
    v_mfma_f32_16x16x32_bf16 a[60:63], v[60:63], v[148:151], a[60:63]
    v_perm_b32 v64, v76, v72, s56
    v_perm_b32 v65, v85, v81, s56
    v_mfma_f32_16x16x32_bf16 a[36:39], v[32:35], v[104:107], a[36:39]
    v_mfma_f32_16x16x32_bf16 a[44:47], v[32:35], v[112:115], a[44:47]
    v_perm_b32 v66, v94, v90, s56
    v_mfma_f32_16x16x32_bf16 a[52:55], v[32:35], v[120:123], a[52:55]
    buffer_load_dwordx4 v18, s[4:7], s59 offen offset:3072 lds
    v_mfma_f32_16x16x32_bf16 a[60:63], v[32:35], v[128:131], a[60:63]
    v_perm_b32 v67, v103, v99, s56
    v_mfma_f32_16x16x32_bf16 a[32:35], v[32:35], v[200:203], a[32:35]
    v_mfma_f32_16x16x32_bf16 a[40:43], v[32:35], v[204:207], a[40:43]
    buffer_load_dwordx4 v[196:199], v13, s[8:11], s60 offen offset:256 sc1
    v_mfma_f32_16x16x32_bf16 a[48:51], v[32:35], v[208:211], a[48:51]
    s_add_u32 s60, s60, 262144
    s_add_u32 m0, s61, 114688
    v_mfma_f32_16x16x32_bf16 a[56:59], v[32:35], v[212:215], a[56:59]
    v_mfma_f32_16x16x32_bf16 a[36:39], v[44:47], v[112:115], a[36:39]
    v_mfma_f32_16x16x32_bf16 a[44:47], v[44:47], v[120:123], a[44:47]
    buffer_load_dwordx4 v19, s[4:7], s59 offen offset:0 lds
    v_mfma_f32_16x16x32_bf16 a[52:55], v[44:47], v[128:131], a[52:55]
    s_waitcnt vmcnt(12)
    s_barrier
    v_mfma_f32_16x16x32_bf16 a[60:63], v[44:47], v[136:139], a[60:63]
    ds_read_b128 v[68:71], v24 offset:0
    ds_read_b128 v[72:75], v25 offset:0
    v_mfma_f32_16x16x32_bf16 a[32:35], v[44:47], v[204:207], a[32:35]
    ds_read_b128 v[76:79], v26 offset:0
    ds_read_b128 v[80:83], v27 offset:0
    v_mfma_f32_16x16x32_bf16 a[40:43], v[44:47], v[208:211], a[40:43]
    buffer_load_dwordx4 v20, s[4:7], s59 offen offset:1024 lds
    v_mfma_f32_16x16x32_bf16 a[48:51], v[44:47], v[212:215], a[48:51]
    ds_read_b128 v[84:87], v28 offset:0
    ds_read_b128 v[88:91], v29 offset:0
    v_mfma_f32_16x16x32_bf16 a[56:59], v[44:47], v[216:219], a[56:59]
    ds_read_b128 v[92:95], v30 offset:0
    v_mfma_f32_16x16x32_bf16 a[36:39], v[56:59], v[120:123], a[36:39]
    ds_read_b128 v[96:99], v31 offset:0
    v_mfma_f32_16x16x32_bf16 a[44:47], v[56:59], v[128:131], a[44:47]
    buffer_load_dwordx4 v21, s[4:7], s59 offen offset:2048 lds
    v_mfma_f32_16x16x32_bf16 a[52:55], v[56:59], v[136:139], a[52:55]
    ds_read_b128 v[100:103], v24 offset:1024
    v_mfma_f32_16x16x32_bf16 a[60:63], v[56:59], v[144:147], a[60:63]
    v_mfma_f32_16x16x32_bf16 a[32:35], v[56:59], v[208:211], a[32:35]
    v_mfma_f32_16x16x32_bf16 a[40:43], v[56:59], v[212:215], a[40:43]
    buffer_load_dwordx4 v22, s[4:7], s59 offen offset:3072 lds
    v_mfma_f32_16x16x32_bf16 a[48:51], v[56:59], v[216:219], a[48:51]
    s_add_u32 m0, s61, 118784
    v_mfma_f32_16x16x32_bf16 a[56:59], v[56:59], v[220:223], a[56:59]
    v_mfma_f32_16x16x32_bf16 a[32:35], v[40:43], v[108:111], a[32:35]
    v_max3_u32 v0, v152, v156, v160
    v_mfma_f32_16x16x32_bf16 a[40:43], v[40:43], v[116:119], a[40:43]
    buffer_load_dwordx4 v23, s[4:7], s59 offen offset:0 lds
    v_mfma_f32_16x16x32_bf16 a[48:51], v[40:43], v[124:127], a[48:51]
    s_waitcnt lgkmcnt(0)
    s_mov_b32 m0, 147456
    v_mfma_f32_16x16x32_bf16 a[56:59], v[40:43], v[132:135], a[56:59]
    v_max3_u32 v0, v0, v164, v168
    v_perm_b32 v36, v73, v68, s57
    v_mfma_f32_16x16x32_bf16 a[36:39], v[40:43], v[224:227], a[36:39]
    v_perm_b32 v37, v82, v77, s57
    v_perm_b32 v38, v91, v86, s57
    v_mfma_f32_16x16x32_bf16 a[44:47], v[40:43], v[228:231], a[44:47]
    s_waitcnt vmcnt(14)
    v_max3_u32 v0, v0, v172, v176
    v_mfma_f32_16x16x32_bf16 a[52:55], v[40:43], v[232:235], a[52:55]
    v_perm_b32 v39, v100, v95, s57
    v_perm_b32 v48, v74, v70, s56
    v_mfma_f32_16x16x32_bf16 a[60:63], v[40:43], v[236:239], a[60:63]
    s_waitcnt vmcnt(11)
    v_max3_u32 v0, v0, v180, v184
    v_mfma_f32_16x16x32_bf16 a[32:35], v[52:55], v[116:119], a[32:35]
    buffer_load_dwordx4 v14, s[12:15], s42 offen offset:0 lds
    v_mfma_f32_16x16x32_bf16 a[40:43], v[52:55], v[124:127], a[40:43]
    v_perm_b32 v49, v83, v79, s56
    v_perm_b32 v50, v92, v88, s56
    v_mfma_f32_16x16x32_bf16 a[48:51], v[52:55], v[132:135], a[48:51]
    s_waitcnt vmcnt(8)
    v_max3_u32 v0, v0, v188, v192
    v_mfma_f32_16x16x32_bf16 a[56:59], v[52:55], v[140:143], a[56:59]
    buffer_load_dwordx4 v14, s[12:15], s42 offen offset:1024 lds
    v_mfma_f32_16x16x32_bf16 a[36:39], v[52:55], v[228:231], a[36:39]
    s_waitcnt vmcnt(7)
    v_max_u32 v0, v0, v196
    v_mfma_f32_16x16x32_bf16 a[44:47], v[52:55], v[232:235], a[44:47]
    v_perm_b32 v51, v101, v97, s56
    v_perm_b32 v60, v76, v71, s57
    v_mfma_f32_16x16x32_bf16 a[52:55], v[52:55], v[236:239], a[52:55]
    buffer_load_dwordx4 v14, s[12:15], s42 offen offset:2048 lds
    v_mfma_f32_16x16x32_bf16 a[60:63], v[52:55], v[240:243], a[60:63]
    v_cmp_eq_u32 vcc, -1, v0
    v_perm_b32 v61, v85, v80, s57
    v_mfma_f32_16x16x32_bf16 a[32:35], v[64:67], v[124:127], a[32:35]
    v_perm_b32 v62, v94, v89, s57
    v_perm_b32 v63, v103, v98, s57
    v_mfma_f32_16x16x32_bf16 a[40:43], v[64:67], v[132:135], a[40:43]
    buffer_load_dwordx4 v14, s[12:15], s42 offen offset:3072 lds
    v_mfma_f32_16x16x32_bf16 a[48:51], v[64:67], v[140:143], a[48:51]
    s_add_u32 s42, s42, 4096
    v_mfma_f32_16x16x32_bf16 a[56:59], v[64:67], v[148:151], a[56:59]
    s_add_u32 s59, s59, 4294822144
    s_bitcmp0_b32 s58, 0
    s_cselect_b32 s59, s59, s63
    v_mfma_f32_16x16x32_bf16 a[36:39], v[64:67], v[232:235], a[36:39]
    s_cmp_lt_u32 s58, 1
    s_cselect_b32 s4, s40, s48
    s_cselect_b32 s5, s41, s49
    v_mfma_f32_16x16x32_bf16 a[44:47], v[64:67], v[236:239], a[44:47]
    s_cmp_lg_u64 vcc, 0
    s_cbranch_scc1 L_retry0
L_back0:
    v_mfma_f32_16x16x32_bf16 a[52:55], v[64:67], v[240:243], a[52:55]
    s_cmp_lt_u32 s58, 3
    s_cselect_b32 s6, 4726784, 0
    s_add_u32 m0, s61, 0
    v_mfma_f32_16x16x32_bf16 a[60:63], v[64:67], v[244:247], a[60:63]
    v_mfma_f32_16x16x32_bf16 a[0:3], v[36:39], v[152:155], a[0:3]
    v_perm_b32 v32, v72, v68, s56
    v_perm_b32 v33, v81, v77, s56
    v_mfma_f32_16x16x32_bf16 a[8:11], v[36:39], v[160:163], a[8:11]
    v_perm_b32 v34, v90, v86, s56
    v_perm_b32 v35, v99, v95, s56
    v_mfma_f32_16x16x32_bf16 a[16:19], v[36:39], v[168:171], a[16:19]
    v_perm_b32 v44, v74, v69, s57
    v_mov_b32_dpp v200, v156 row_shr:1 row_mask:0xf bank_mask:0xf bound_ctrl:0
    v_mfma_f32_16x16x32_bf16 a[24:27], v[36:39], v[176:179], a[24:27]
    buffer_load_dwordx4 v2, s[4:7], s59 offen offset:0 lds
    v_mfma_f32_16x16x32_bf16 a[4:7], v[36:39], v[156:159], a[4:7]
    v_perm_b32 v45, v83, v78, s57
    v_mov_b32_dpp v201, v157 row_shr:1 row_mask:0xf bank_mask:0xf bound_ctrl:0
    v_mfma_f32_16x16x32_bf16 a[12:15], v[36:39], v[164:167], a[12:15]
    v_perm_b32 v46, v92, v87, s57
    v_mov_b32_dpp v202, v158 row_shr:1 row_mask:0xf bank_mask:0xf bound_ctrl:0
    v_mfma_f32_16x16x32_bf16 a[20:23], v[36:39], v[172:175], a[20:23]
    buffer_load_dwordx4 v16, s[4:7], s59 offen offset:1024 lds
    v_mfma_f32_16x16x32_bf16 a[28:31], v[36:39], v[180:183], a[28:31]
    s_bitcmp0_b32 s58, 0
    s_cselect_b32 s10, 1048576, 0
    v_mfma_f32_16x16x32_bf16 a[0:3], v[48:51], v[160:163], a[0:3]
    v_perm_b32 v47, v101, v96, s57
    v_perm_b32 v56, v75, v71, s56
    v_mfma_f32_16x16x32_bf16 a[8:11], v[48:51], v[168:171], a[8:11]
    v_perm_b32 v57, v84, v80, s56
    v_mov_b32_dpp v203, v159 row_shr:1 row_mask:0xf bank_mask:0xf bound_ctrl:0
    v_mfma_f32_16x16x32_bf16 a[16:19], v[48:51], v[176:179], a[16:19]
    buffer_load_dwordx4 v[104:107], v12, s[8:11], s60 offen offset:0 sc1
    v_mfma_f32_16x16x32_bf16 a[24:27], v[48:51], v[184:187], a[24:27]
    v_perm_b32 v58, v93, v89, s56
    v_perm_b32 v59, v102, v98, s56
    v_mfma_f32_16x16x32_bf16 a[4:7], v[48:51], v[164:167], a[4:7]
    v_mov_b32_dpp v204, v164 row_shr:1 row_mask:0xf bank_mask:0xf bound_ctrl:0
    v_mov_b32_dpp v205, v165 row_shr:1 row_mask:0xf bank_mask:0xf bound_ctrl:0
    v_mfma_f32_16x16x32_bf16 a[12:15], v[48:51], v[172:175], a[12:15]
    v_mov_b32_dpp v206, v166 row_shr:1 row_mask:0xf bank_mask:0xf bound_ctrl:0
    v_mov_b32_dpp v207, v167 row_shr:1 row_mask:0xf bank_mask:0xf bound_ctrl:0
    v_mfma_f32_16x16x32_bf16 a[20:23], v[48:51], v[180:183], a[20:23]
    buffer_load_dwordx4 v17, s[4:7], s59 offen offset:2048 lds
    v_mfma_f32_16x16x32_bf16 a[28:31], v[48:51], v[188:191], a[28:31]
    v_mov_b32_dpp v208, v172 row_shr:1 row_mask:0xf bank_mask:0xf bound_ctrl:0
    v_mov_b32_dpp v209, v173 row_shr:1 row_mask:0xf bank_mask:0xf bound_ctrl:0
    v_mfma_f32_16x16x32_bf16 a[0:3], v[60:63], v[168:171], a[0:3]
    v_mov_b32_dpp v210, v174 row_shr:1 row_mask:0xf bank_mask:0xf bound_ctrl:0
    v_mov_b32_dpp v211, v175 row_shr:1 row_mask:0xf bank_mask:0xf bound_ctrl:0
    v_mfma_f32_16x16x32_bf16 a[8:11], v[60:63], v[176:179], a[8:11]
    v_mov_b32_dpp v212, v180 row_shr:1 row_mask:0xf bank_mask:0xf bound_ctrl:0
    v_mov_b32_dpp v213, v181 row_shr:1 row_mask:0xf bank_mask:0xf bound_ctrl:0
    v_mfma_f32_16x16x32_bf16 a[16:19], v[60:63], v[184:187], a[16:19]
    buffer_load_dwordx4 v18, s[4:7], s59 offen offset:3072 lds
    v_mfma_f32_16x16x32_bf16 a[24:27], v[60:63], v[192:195], a[24:27]
    v_mov_b32_dpp v214, v182 row_shr:1 row_mask:0xf bank_mask:0xf bound_ctrl:0
    v_mov_b32_dpp v215, v183 row_shr:1 row_mask:0xf bank_mask:0xf bound_ctrl:0
    v_mfma_f32_16x16x32_bf16 a[4:7], v[60:63], v[172:175], a[4:7]
    v_perm_b32 v40, v73, v69, s56
    v_perm_b32 v41, v82, v78, s56
    v_mfma_f32_16x16x32_bf16 a[12:15], v[60:63], v[180:183], a[12:15]
    v_perm_b32 v42, v91, v87, s56
    v_perm_b32 v43, v100, v96, s56
    v_mfma_f32_16x16x32_bf16 a[20:23], v[60:63], v[188:191], a[20:23]
    buffer_load_dwordx4 v[108:111], v12, s[8:11], s60 offen offset:256 sc1
    v_mfma_f32_16x16x32_bf16 a[28:31], v[60:63], v[196:199], a[28:31]
    s_add_u32 m0, s61, 4096
    v_perm_b32 v52, v75, v70, s57
    v_mfma_f32_16x16x32_bf16 a[4:7], v[32:35], v[152:155], a[4:7]
    v_perm_b32 v53, v84, v79, s57
    v_perm_b32 v54, v93, v88, s57
    v_mfma_f32_16x16x32_bf16 a[12:15], v[32:35], v[160:163], a[12:15]
    v_perm_b32 v55, v102, v97, s57
    v_perm_b32 v64, v76, v72, s56
    v_mfma_f32_16x16x32_bf16 a[20:23], v[32:35], v[168:171], a[20:23]
    buffer_load_dwordx4 v19, s[4:7], s59 offen offset:0 lds
    v_mfma_f32_16x16x32_bf16 a[28:31], v[32:35], v[176:179], a[28:31]
    v_perm_b32 v65, v85, v81, s56
    v_perm_b32 v66, v94, v90, s56
    v_mfma_f32_16x16x32_bf16 a[0:3], v[32:35], v[200:203], a[0:3]
    v_perm_b32 v67, v103, v99, s56
    v_mov_b32_dpp v216, v188 row_shr:1 row_mask:0xf bank_mask:0xf bound_ctrl:0
    v_mfma_f32_16x16x32_bf16 a[8:11], v[32:35], v[204:207], a[8:11]
    v_mov_b32_dpp v217, v189 row_shr:1 row_mask:0xf bank_mask:0xf bound_ctrl:0
    v_mov_b32_dpp v218, v190 row_shr:1 row_mask:0xf bank_mask:0xf bound_ctrl:0
    v_mfma_f32_16x16x32_bf16 a[16:19], v[32:35], v[208:211], a[16:19]
    buffer_load_dwordx4 v[112:115], v11, s[8:11], s60 offen offset:0 sc1
    v_mfma_f32_16x16x32_bf16 a[24:27], v[32:35], v[212:215], a[24:27]
    v_mov_b32_dpp v219, v191 row_shr:1 row_mask:0xf bank_mask:0xf bound_ctrl:0
    v_mov_b32_dpp v220, v196 row_shr:1 row_mask:0xf bank_mask:0xf bound_ctrl:0
    v_mfma_f32_16x16x32_bf16 a[4:7], v[44:47], v[160:163], a[4:7]
    v_mov_b32_dpp v221, v197 row_shr:1 row_mask:0xf bank_mask:0xf bound_ctrl:0
    v_mov_b32_dpp v222, v198 row_shr:1 row_mask:0xf bank_mask:0xf bound_ctrl:0
    v_mfma_f32_16x16x32_bf16 a[12:15], v[44:47], v[168:171], a[12:15]
    s_waitcnt vmcnt(12)
    s_barrier
    v_mfma_f32_16x16x32_bf16 a[20:23], v[44:47], v[176:179], a[20:23]
    buffer_load_dwordx4 v20, s[4:7], s59 offen offset:1024 lds
    v_mfma_f32_16x16x32_bf16 a[28:31], v[44:47], v[184:187], a[28:31]
    v_mov_b32_dpp v223, v199 row_shr:1 row_mask:0xf bank_mask:0xf bound_ctrl:0
    ds_read_b128 v[68:71], v24 offset:36864
    v_mfma_f32_16x16x32_bf16 a[0:3], v[44:47], v[204:207], a[0:3]
    ds_read_b128 v[72:75], v25 offset:36864
    ds_read_b128 v[76:79], v26 offset:36864
    v_mfma_f32_16x16x32_bf16 a[8:11], v[44:47], v[208:211], a[8:11]
    buffer_load_dwordx4 v[116:119], v11, s[8:11], s60 offen offset:256 sc1
    v_mfma_f32_16x16x32_bf16 a[16:19], v[44:47], v[212:215], a[16:19]
    ds_read_b128 v[80:83], v27 offset:36864
    ds_read_b128 v[84:87], v28 offset:36864
    v_mfma_f32_16x16x32_bf16 a[24:27], v[44:47], v[216:219], a[24:27]
    ds_read_b128 v[88:91], v29 offset:36864
    ds_read_b128 v[92:95], v30 offset:36864
    v_mfma_f32_16x16x32_bf16 a[4:7], v[56:59], v[168:171], a[4:7]
    ds_read_b128 v[96:99], v31 offset:36864
    v_mov_b32_dpp v224, v152 row_shl:1 row_mask:0xf bank_mask:0xf bound_ctrl:0
    v_mfma_f32_16x16x32_bf16 a[12:15], v[56:59], v[176:179], a[12:15]
    buffer_load_dwordx4 v21, s[4:7], s59 offen offset:2048 lds
    v_mfma_f32_16x16x32_bf16 a[20:23], v[56:59], v[184:187], a[20:23]
    ds_read_b128 v[100:103], v24 offset:37888
    v_mov_b32_dpp v225, v153 row_shl:1 row_mask:0xf bank_mask:0xf bound_ctrl:0
    v_mfma_f32_16x16x32_bf16 a[28:31], v[56:59], v[192:195], a[28:31]
    v_mov_b32_dpp v226, v154 row_shl:1 row_mask:0xf bank_mask:0xf bound_ctrl:0
    v_mov_b32_dpp v227, v155 row_shl:1 row_mask:0xf bank_mask:0xf bound_ctrl:0
    v_mfma_f32_16x16x32_bf16 a[0:3], v[56:59], v[208:211], a[0:3]
    v_mov_b32_dpp v228, v160 row_shl:1 row_mask:0xf bank_mask:0xf bound_ctrl:0
    v_mov_b32_dpp v229, v161 row_shl:1 row_mask:0xf bank_mask:0xf bound_ctrl:0
    v_mfma_f32_16x16x32_bf16 a[8:11], v[56:59], v[212:215], a[8:11]
    buffer_load_dwordx4 v[120:123], v11, s[8:11], s60 offen offset:512 sc1
    v_mfma_f32_16x16x32_bf16 a[16:19], v[56:59], v[216:219], a[16:19]
    v_mov_b32_dpp v230, v162 row_shl:1 row_mask:0xf bank_mask:0xf bound_ctrl:0
    v_mov_b32_dpp v231, v163 row_shl:1 row_mask:0xf bank_mask:0xf bound_ctrl:0
    v_mfma_f32_16x16x32_bf16 a[24:27], v[56:59], v[220:223], a[24:27]
    v_mov_b32_dpp v232, v168 row_shl:1 row_mask:0xf bank_mask:0xf bound_ctrl:0
    v_mov_b32_dpp v233, v169 row_shl:1 row_mask:0xf bank_mask:0xf bound_ctrl:0
    v_mfma_f32_16x16x32_bf16 a[0:3], v[40:43], v[156:159], a[0:3]
    v_mov_b32_dpp v234, v170 row_shl:1 row_mask:0xf bank_mask:0xf bound_ctrl:0
    v_mov_b32_dpp v235, v171 row_shl:1 row_mask:0xf bank_mask:0xf bound_ctrl:0
    v_mov_b32_dpp v236, v176 row_shl:1 row_mask:0xf bank_mask:0xf bound_ctrl:0
    v_mov_b32_dpp v237, v177 row_shl:1 row_mask:0xf bank_mask:0xf bound_ctrl:0
    v_mov_b32_dpp v238, v178 row_shl:1 row_mask:0xf bank_mask:0xf bound_ctrl:0
    v_mov_b32_dpp v239, v179 row_shl:1 row_mask:0xf bank_mask:0xf bound_ctrl:0
    v_mfma_f32_16x16x32_bf16 a[8:11], v[40:43], v[164:167], a[8:11]
    buffer_load_dwordx4 v22, s[4:7], s59 offen offset:3072 lds
    v_mfma_f32_16x16x32_bf16 a[16:19], v[40:43], v[172:175], a[16:19]
    s_add_u32 m0, s61, 8192
    s_waitcnt lgkmcnt(0)
    v_mfma_f32_16x16x32_bf16 a[24:27], v[40:43], v[180:183], a[24:27]
    v_mov_b32_dpp v240, v184 row_shl:1 row_mask:0xf bank_mask:0xf bound_ctrl:0
    v_mov_b32_dpp v241, v185 row_shl:1 row_mask:0xf bank_mask:0xf bound_ctrl:0
    v_mfma_f32_16x16x32_bf16 a[4:7], v[40:43], v[224:227], a[4:7]
    v_mov_b32_dpp v242, v186 row_shl:1 row_mask:0xf bank_mask:0xf bound_ctrl:0
    v_mov_b32_dpp v243, v187 row_shl:1 row_mask:0xf bank_mask:0xf bound_ctrl:0
    v_mfma_f32_16x16x32_bf16 a[12:15], v[40:43], v[228:231], a[12:15]
    buffer_load_dwordx4 v23, s[4:7], s59 offen offset:0 lds
    v_mfma_f32_16x16x32_bf16 a[20:23], v[40:43], v[232:235], a[20:23]
    v_mov_b32_dpp v244, v192 row_shl:1 row_mask:0xf bank_mask:0xf bound_ctrl:0
    v_mov_b32_dpp v245, v193 row_shl:1 row_mask:0xf bank_mask:0xf bound_ctrl:0
    v_mfma_f32_16x16x32_bf16 a[28:31], v[40:43], v[236:239], a[28:31]
    v_mov_b32_dpp v246, v194 row_shl:1 row_mask:0xf bank_mask:0xf bound_ctrl:0
    v_mov_b32_dpp v247, v195 row_shl:1 row_mask:0xf bank_mask:0xf bound_ctrl:0
    v_mfma_f32_16x16x32_bf16 a[0:3], v[52:55], v[164:167], a[0:3]
    v_perm_b32 v36, v73, v68, s57
    v_perm_b32 v37, v82, v77, s57
    v_mfma_f32_16x16x32_bf16 a[8:11], v[52:55], v[172:175], a[8:11]
    buffer_load_dwordx4 v[124:127], v11, s[8:11], s60 offen offset:768 sc1
    v_mfma_f32_16x16x32_bf16 a[16:19], v[52:55], v[180:183], a[16:19]
    v_perm_b32 v38, v91, v86, s57
    v_perm_b32 v39, v100, v95, s57
    v_mfma_f32_16x16x32_bf16 a[24:27], v[52:55], v[188:191], a[24:27]
    v_perm_b32 v48, v74, v70, s56
    v_perm_b32 v49, v83, v79, s56
    v_mfma_f32_16x16x32_bf16 a[4:7], v[52:55], v[228:231], a[4:7]
    v_perm_b32 v50, v92, v88, s56
    v_perm_b32 v51, v101, v97, s56
    v_mfma_f32_16x16x32_bf16 a[12:15], v[52:55], v[232:235], a[12:15]
    buffer_load_dwordx4 v[128:131], v11, s[8:11], s60 offen offset:1024 sc1
    v_mfma_f32_16x16x32_bf16 a[20:23], v[52:55], v[236:239], a[20:23]
    v_perm_b32 v60, v76, v71, s57
    v_perm_b32 v61, v85, v80, s57
    v_mfma_f32_16x16x32_bf16 a[28:31], v[52:55], v[240:243], a[28:31]
    v_perm_b32 v62, v94, v89, s57
    v_perm_b32 v63, v103, v98, s57
    v_mfma_f32_16x16x32_bf16 a[0:3], v[64:67], v[172:175], a[0:3]
    v_mfma_f32_16x16x32_bf16 a[8:11], v[64:67], v[180:183], a[8:11]
    buffer_load_dwordx4 v[132:135], v11, s[8:11], s60 offen offset:1280 sc1
    v_mfma_f32_16x16x32_bf16 a[16:19], v[64:67], v[188:191], a[16:19]
    s_add_u32 s59, s59, 147456
    s_add_u32 m0, s61, 36864
    v_mfma_f32_16x16x32_bf16 a[24:27], v[64:67], v[196:199], a[24:27]
    v_mfma_f32_16x16x32_bf16 a[4:7], v[64:67], v[232:235], a[4:7]
    v_mfma_f32_16x16x32_bf16 a[12:15], v[64:67], v[236:239], a[12:15]
    v_mfma_f32_16x16x32_bf16 a[20:23], v[64:67], v[240:243], a[20:23]
    v_mfma_f32_16x16x32_bf16 a[28:31], v[64:67], v[244:247], a[28:31]
    v_mfma_f32_16x16x32_bf16 a[32:35], v[36:39], v[152:155], a[32:35]
    v_perm_b32 v32, v72, v68, s56
    v_perm_b32 v33, v81, v77, s56
    v_mfma_f32_16x16x32_bf16 a[40:43], v[36:39], v[160:163], a[40:43]
    v_perm_b32 v34, v90, v86, s56
    v_perm_b32 v35, v99, v95, s56
    v_mfma_f32_16x16x32_bf16 a[48:51], v[36:39], v[168:171], a[48:51]
    v_perm_b32 v44, v74, v69, s57
    v_mfma_f32_16x16x32_bf16 a[56:59], v[36:39], v[176:179], a[56:59]
    buffer_load_dwordx4 v2, s[4:7], s59 offen offset:0 lds
    v_mfma_f32_16x16x32_bf16 a[36:39], v[36:39], v[156:159], a[36:39]
    v_perm_b32 v45, v83, v78, s57
    v_mfma_f32_16x16x32_bf16 a[44:47], v[36:39], v[164:167], a[44:47]
    v_perm_b32 v46, v92, v87, s57
    v_mfma_f32_16x16x32_bf16 a[52:55], v[36:39], v[172:175], a[52:55]
    buffer_load_dwordx4 v[136:139], v11, s[8:11], s60 offen offset:1536 sc1
    v_mfma_f32_16x16x32_bf16 a[60:63], v[36:39], v[180:183], a[60:63]
    v_perm_b32 v47, v101, v96, s57
    v_perm_b32 v56, v75, v71, s56
    v_mfma_f32_16x16x32_bf16 a[32:35], v[48:51], v[160:163], a[32:35]
    v_mfma_f32_16x16x32_bf16 a[40:43], v[48:51], v[168:171], a[40:43]
    v_perm_b32 v57, v84, v80, s56
    v_mfma_f32_16x16x32_bf16 a[48:51], v[48:51], v[176:179], a[48:51]
    buffer_load_dwordx4 v16, s[4:7], s59 offen offset:1024 lds
    v_mfma_f32_16x16x32_bf16 a[56:59], v[48:51], v[184:187], a[56:59]
    v_perm_b32 v58, v93, v89, s56
    v_perm_b32 v59, v102, v98, s56
    v_mfma_f32_16x16x32_bf16 a[36:39], v[48:51], v[164:167], a[36:39]
    v_mfma_f32_16x16x32_bf16 a[44:47], v[48:51], v[172:175], a[44:47]
    v_mfma_f32_16x16x32_bf16 a[52:55], v[48:51], v[180:183], a[52:55]
    buffer_load_dwordx4 v[140:143], v11, s[8:11], s60 offen offset:1792 sc1
    v_mfma_f32_16x16x32_bf16 a[60:63], v[48:51], v[188:191], a[60:63]
    v_perm_b32 v40, v73, v69, s56
    v_perm_b32 v41, v82, v78, s56
    v_mfma_f32_16x16x32_bf16 a[32:35], v[60:63], v[168:171], a[32:35]
    v_perm_b32 v42, v91, v87, s56
    v_perm_b32 v43, v100, v96, s56
    v_mfma_f32_16x16x32_bf16 a[40:43], v[60:63], v[176:179], a[40:43]
    v_perm_b32 v52, v75, v70, s57
    v_mfma_f32_16x16x32_bf16 a[48:51], v[60:63], v[184:187], a[48:51]
    buffer_load_dwordx4 v17, s[4:7], s59 offen offset:2048 lds
    v_mfma_f32_16x16x32_bf16 a[56:59], v[60:63], v[192:195], a[56:59]
    v_perm_b32 v53, v84, v79, s57
    v_perm_b32 v54, v93, v88, s57
    v_mfma_f32_16x16x32_bf16 a[36:39], v[60:63], v[172:175], a[36:39]
    v_perm_b32 v55, v102, v97, s57
    v_mfma_f32_16x16x32_bf16 a[44:47], v[60:63], v[180:183], a[44:47]
    v_mfma_f32_16x16x32_bf16 a[52:55], v[60:63], v[188:191], a[52:55]
    buffer_load_dwordx4 v[144:147], v13, s[8:11], s60 offen offset:0 sc1
    v_mfma_f32_16x16x32_bf16 a[60:63], v[60:63], v[196:199], a[60:63]
    v_perm_b32 v64, v76, v72, s56
    v_perm_b32 v65, v85, v81, s56
    v_mfma_f32_16x16x32_bf16 a[36:39], v[32:35], v[152:155], a[36:39]
    v_mfma_f32_16x16x32_bf16 a[44:47], v[32:35], v[160:163], a[44:47]
    v_perm_b32 v66, v94, v90, s56
    v_mfma_f32_16x16x32_bf16 a[52:55], v[32:35], v[168:171], a[52:55]
    buffer_load_dwordx4 v18, s[4:7], s59 offen offset:3072 lds
    v_mfma_f32_16x16x32_bf16 a[60:63], v[32:35], v[176:179], a[60:63]
    v_perm_b32 v67, v103, v99, s56
    v_mfma_f32_16x16x32_bf16 a[32:35], v[32:35], v[200:203], a[32:35]
    v_mfma_f32_16x16x32_bf16 a[40:43], v[32:35], v[204:207], a[40:43]
    buffer_load_dwordx4 v[148:151], v13, s[8:11], s60 offen offset:256 sc1
    v_mfma_f32_16x16x32_bf16 a[48:51], v[32:35], v[208:211], a[48:51]
    s_add_u32 s60, s60, 262144
    s_add_u32 m0, s61, 40960
    v_mfma_f32_16x16x32_bf16 a[56:59], v[32:35], v[212:215], a[56:59]
    v_mfma_f32_16x16x32_bf16 a[36:39], v[44:47], v[160:163], a[36:39]
    v_mfma_f32_16x16x32_bf16 a[44:47], v[44:47], v[168:171], a[44:47]
    buffer_load_dwordx4 v19, s[4:7], s59 offen offset:0 lds
    v_mfma_f32_16x16x32_bf16 a[52:55], v[44:47], v[176:179], a[52:55]
    s_waitcnt vmcnt(12)
    s_barrier
    v_mfma_f32_16x16x32_bf16 a[60:63], v[44:47], v[184:187], a[60:63]
    ds_read_b128 v[68:71], v3 offset:0
    ds_read_b128 v[72:75], v4 offset:0
    v_mfma_f32_16x16x32_bf16 a[32:35], v[44:47], v[204:207], a[32:35]
    ds_read_b128 v[76:79], v5 offset:0
    ds_read_b128 v[80:83], v6 offset:0
    v_mfma_f32_16x16x32_bf16 a[40:43], v[44:47], v[208:211], a[40:43]
    buffer_load_dwordx4 v20, s[4:7], s59 offen offset:1024 lds
    v_mfma_f32_16x16x32_bf16 a[48:51], v[44:47], v[212:215], a[48:51]
    ds_read_b128 v[84:87], v7 offset:0
    ds_read_b128 v[88:91], v8 offset:0
    v_mfma_f32_16x16x32_bf16 a[56:59], v[44:47], v[216:219], a[56:59]
    ds_read_b128 v[92:95], v9 offset:0
    v_mfma_f32_16x16x32_bf16 a[36:39], v[56:59], v[168:171], a[36:39]
    ds_read_b128 v[96:99], v10 offset:0
    v_mfma_f32_16x16x32_bf16 a[44:47], v[56:59], v[176:179], a[44:47]
    buffer_load_dwordx4 v21, s[4:7], s59 offen offset:2048 lds
    v_mfma_f32_16x16x32_bf16 a[52:55], v[56:59], v[184:187], a[52:55]
    ds_read_b128 v[100:103], v3 offset:1024
    v_mfma_f32_16x16x32_bf16 a[60:63], v[56:59], v[192:195], a[60:63]
    v_mfma_f32_16x16x32_bf16 a[32:35], v[56:59], v[208:211], a[32:35]
    v_mfma_f32_16x16x32_bf16 a[40:43], v[56:59], v[212:215], a[40:43]
    buffer_load_dwordx4 v22, s[4:7], s59 offen offset:3072 lds
    v_mfma_f32_16x16x32_bf16 a[48:51], v[56:59], v[216:219], a[48:51]
    s_add_u32 m0, s61, 45056
    v_mfma_f32_16x16x32_bf16 a[56:59], v[56:59], v[220:223], a[56:59]
    v_mfma_f32_16x16x32_bf16 a[32:35], v[40:43], v[156:159], a[32:35]
    v_max3_u32 v0, v104, v108, v112
    v_mfma_f32_16x16x32_bf16 a[40:43], v[40:43], v[164:167], a[40:43]
    buffer_load_dwordx4 v23, s[4:7], s59 offen offset:0 lds
    v_mfma_f32_16x16x32_bf16 a[48:51], v[40:43], v[172:175], a[48:51]
    s_waitcnt lgkmcnt(0)
    v_max3_u32 v0, v0, v116, v120
    v_mfma_f32_16x16x32_bf16 a[56:59], v[40:43], v[180:183], a[56:59]
    s_mov_b32 s12, s48
    s_mov_b32 s13, s49
    s_mov_b32 s14, s43
    v_mfma_f32_16x16x32_bf16 a[36:39], v[40:43], v[224:227], a[36:39]
    s_mov_b32 m0, 147456
    v_perm_b32 v36, v73, v68, s57
    v_mfma_f32_16x16x32_bf16 a[44:47], v[40:43], v[228:231], a[44:47]
    s_waitcnt vmcnt(14)
    v_max3_u32 v0, v0, v124, v128
    v_mfma_f32_16x16x32_bf16 a[52:55], v[40:43], v[232:235], a[52:55]
    v_perm_b32 v37, v82, v77, s57
    v_perm_b32 v38, v91, v86, s57
    v_mfma_f32_16x16x32_bf16 a[60:63], v[40:43], v[236:239], a[60:63]
    s_waitcnt vmcnt(11)
    v_max3_u32 v0, v0, v132, v136
    v_mfma_f32_16x16x32_bf16 a[32:35], v[52:55], v[164:167], a[32:35]
    buffer_load_dwordx4 v14, s[12:15], s42 offen offset:0 lds
    v_mfma_f32_16x16x32_bf16 a[40:43], v[52:55], v[172:175], a[40:43]
    v_perm_b32 v39, v100, v95, s57
    v_perm_b32 v48, v74, v70, s56
    v_mfma_f32_16x16x32_bf16 a[48:51], v[52:55], v[180:183], a[48:51]
    s_waitcnt vmcnt(8)
    v_max3_u32 v0, v0, v140, v144
    v_mfma_f32_16x16x32_bf16 a[56:59], v[52:55], v[188:191], a[56:59]
    buffer_load_dwordx4 v14, s[12:15], s42 offen offset:1024 lds
    v_mfma_f32_16x16x32_bf16 a[36:39], v[52:55], v[228:231], a[36:39]
    s_waitcnt vmcnt(7)
    v_max_u32 v0, v0, v148
    v_mfma_f32_16x16x32_bf16 a[44:47], v[52:55], v[232:235], a[44:47]
    v_perm_b32 v49, v83, v79, s56
    v_perm_b32 v50, v92, v88, s56
    v_mfma_f32_16x16x32_bf16 a[52:55], v[52:55], v[236:239], a[52:55]
    buffer_load_dwordx4 v14, s[12:15], s42 offen offset:2048 lds
    v_mfma_f32_16x16x32_bf16 a[60:63], v[52:55], v[240:243], a[60:63]
    v_cmp_eq_u32 vcc, -1, v0
    v_perm_b32 v51, v101, v97, s56
    v_mfma_f32_16x16x32_bf16 a[32:35], v[64:67], v[172:175], a[32:35]
    v_perm_b32 v60, v76, v71, s57
    v_perm_b32 v61, v85, v80, s57
    v_mfma_f32_16x16x32_bf16 a[40:43], v[64:67], v[180:183], a[40:43]
    buffer_load_dwordx4 v14, s[12:15], s42 offen offset:3072 lds
    v_mfma_f32_16x16x32_bf16 a[48:51], v[64:67], v[188:191], a[48:51]
    v_perm_b32 v62, v94, v89, s57
    v_perm_b32 v63, v103, v98, s57
    v_mfma_f32_16x16x32_bf16 a[56:59], v[64:67], v[196:199], a[56:59]
    s_add_u32 s42, s42, 4096
    s_mov_b32 s14, 0
    s_mov_b32 s43, 0
    v_mfma_f32_16x16x32_bf16 a[36:39], v[64:67], v[232:235], a[36:39]
    v_mfma_f32_16x16x32_bf16 a[44:47], v[64:67], v[236:239], a[44:47]
    s_cmp_lg_u64 vcc, 0
    s_cbranch_scc1 L_retry1
L_back1:
    v_mfma_f32_16x16x32_bf16 a[52:55], v[64:67], v[240:243], a[52:55]
    v_mfma_f32_16x16x32_bf16 a[60:63], v[64:67], v[244:247], a[60:63]
    s_add_u32 s58, s58, 1
    s_bitcmp1_b32 s58, 0
    s_cbranch_scc1 L_conv_4
    s_cmp_lg_u32 s31, 0
    s_cbranch_scc1 L_noeg
    s_lshl_b32 s75, s24, 4
    s_lshr_b32 s68, s28, 5
    s_add_u32 s75, s75, s68
    s_lshl_b32 s75, s75, 13
    s_lshl_b32 s68, s3, 11
    s_add_u32 s75, s75, s68
    s_add_u32 s75, s75, 8454144
    v_lshlrev_b32 v176, 4, v1
    buffer_load_dwordx4 v[168:171], v176, s[16:19], s75 offen sc1
    buffer_load_dwordx4 v[172:175], v176, s[16:19], s75 offen offset:1024 sc1
    s_mov_b32 s14, 4726784
    s_sub_u32 s42, s42, 8192
    s_add_u32 s67, s42, 4096
    s_mov_b32 m0, 147456
    s_nop 0
    buffer_load_dwordx4 v14, s[12:15], s42 offen lds
    buffer_load_dwordx4 v14, s[12:15], s42 offen offset:1024 lds
    buffer_load_dwordx4 v14, s[12:15], s42 offen offset:2048 lds
    buffer_load_dwordx4 v14, s[12:15], s42 offen offset:3072 lds
    buffer_load_dwordx4 v14, s[12:15], s67 offen lds
L_noeg:
    v_accvgpr_read_b32 v236, a65
    v_accvgpr_read_b32 v240, a66
    v_accvgpr_read_b32 v241, a67
    ds_write_b128 v236, a[0:3] offset:0
    ds_write_b128 v236, a[4:7] offset:1088
    ds_write_b128 v236, a[8:11] offset:2176
    ds_write_b128 v236, a[12:15] offset:3264
    ds_write_b128 v236, a[16:19] offset:4352
    ds_write_b128 v236, a[20:23] offset:5440
    ds_write_b128 v236, a[24:27] offset:6528
    ds_write_b128 v236, a[28:31] offset:7616
    ds_write_b128 v236, a[32:35] offset:36864
    ds_write_b128 v236, a[36:39] offset:37952
    ds_write_b128 v236, a[40:43] offset:39040
    ds_write_b128 v236, a[44:47] offset:40128
    ds_write_b128 v236, a[48:51] offset:41216
    ds_write_b128 v236, a[52:55] offset:42304
    ds_write_b128 v236, a[56:59] offset:43392
    ds_write_b128 v236, a[60:63] offset:44480
    s_waitcnt lgkmcnt(0)
    s_barrier
    ds_read_b128 v[104:107], v240 offset:0
    ds_read_b128 v[108:111], v241 offset:0
    ds_read_b128 v[112:115], v240 offset:1088
    ds_read_b128 v[116:119], v241 offset:1088
    ds_read_b128 v[120:123], v240 offset:8704
    ds_read_b128 v[124:127], v241 offset:8704
    ds_read_b128 v[128:131], v240 offset:9792
    ds_read_b128 v[132:135], v241 offset:9792
    ds_read_b128 v[136:139], v240 offset:17408
    ds_read_b128 v[140:143], v241 offset:17408
    ds_read_b128 v[144:147], v240 offset:18496
    ds_read_b128 v[148:151], v241 offset:18496
    ds_read_b128 v[152:155], v240 offset:26112
    ds_read_b128 v[156:159], v241 offset:26112
    ds_read_b128 v[160:163], v240 offset:27200
    ds_read_b128 v[164:167], v241 offset:27200
    s_waitcnt lgkmcnt(8)
    v_add_f32 v104, v104, v120
    v_add_f32 v105, v105, v121
    v_add_f32 v106, v106, v122
    v_add_f32 v107, v107, v123
    v_add_f32 v108, v108, v124
    v_add_f32 v109, v109, v125
    v_add_f32 v110, v110, v126
    v_add_f32 v111, v111, v127
    v_add_f32 v112, v112, v128
    v_add_f32 v113, v113, v129
    v_add_f32 v114, v114, v130
    v_add_f32 v115, v115, v131
    v_add_f32 v116, v116, v132
    v_add_f32 v117, v117, v133
    v_add_f32 v118, v118, v134
    v_add_f32 v119, v119, v135
    s_waitcnt lgkmcnt(4)
    v_add_f32 v104, v104, v136
    v_add_f32 v105, v105, v137
    v_add_f32 v106, v106, v138
    v_add_f32 v107, v107, v139
    v_add_f32 v108, v108, v140
    v_add_f32 v109, v109, v141
    v_add_f32 v110, v110, v142
    v_add_f32 v111, v111, v143
    v_add_f32 v112, v112, v144
    v_add_f32 v113, v113, v145
    v_add_f32 v114, v114, v146
    v_add_f32 v115, v115, v147
    v_add_f32 v116, v116, v148
    v_add_f32 v117, v117, v149
    v_add_f32 v118, v118, v150
    v_add_f32 v119, v119, v151
    s_waitcnt lgkmcnt(0)
    v_add_f32 v200, v104, v152
    v_add_f32 v202, v105, v153
    v_add_f32 v204, v106, v154
    v_add_f32 v206, v107, v155
    v_add_f32 v208, v108, v156
    v_add_f32 v210, v109, v157
    v_add_f32 v212, v110, v158
    v_add_f32 v214, v111, v159
    v_add_f32 v201, v112, v160
    v_add_f32 v203, v113, v161
    v_add_f32 v205, v114, v162
    v_add_f32 v207, v115, v163
    v_add_f32 v209, v116, v164
    v_add_f32 v211, v117, v165
    v_add_f32 v213, v118, v166
    v_add_f32 v215, v119, v167
    s_cmp_lg_u32 s31, 0
    s_cbranch_scc1 L_final
    s_mov_b32 s73, 0
    s_waitcnt vmcnt(5)
    s_branch L_pemb_c_7
L_pemb_5:
    s_waitcnt vmcnt(0)
L_pemb_c_7:
    v_cmp_ne_u32 vcc, s30, v169
    v_cmp_ne_u32_e64 s[52:53], s30, v171
    s_nop 0
    s_or_b64 vcc, vcc, s[52:53]
    v_cmp_ne_u32_e64 s[52:53], s30, v173
    s_nop 0
    s_or_b64 vcc, vcc, s[52:53]
    v_cmp_ne_u32_e64 s[52:53], s30, v175
    s_nop 0
    s_or_b64 vcc, vcc, s[52:53]
    s_cmp_eq_u64 vcc, 0
    s_cbranch_scc1 L_pemb_done_6
    s_sleep 1
    buffer_load_dwordx4 v[168:171], v176, s[16:19], s75 offen sc1
    buffer_load_dwordx4 v[172:175], v176, s[16:19], s75 offen offset:1024 sc1
    s_add_u32 s73, s73, 1
    s_cmp_lt_u32 s73, 0x40000
    s_cbranch_scc1 L_pemb_5
L_pemb_done_6:
    v_add_f32_dpp v168, v168, v168 row_shr:1 row_mask:0xf bank_mask:0xf bound_ctrl:0
    v_add_f32_dpp v170, v170, v170 row_shr:1 row_mask:0xf bank_mask:0xf bound_ctrl:0
    v_add_f32_dpp v172, v172, v172 row_shr:1 row_mask:0xf bank_mask:0xf bound_ctrl:0
    v_add_f32_dpp v174, v174, v174 row_shr:1 row_mask:0xf bank_mask:0xf bound_ctrl:0
    v_add_f32_dpp v168, v168, v168 row_shr:2 row_mask:0xf bank_mask:0xf bound_ctrl:0
    v_add_f32_dpp v170, v170, v170 row_shr:2 row_mask:0xf bank_mask:0xf bound_ctrl:0
    v_add_f32_dpp v172, v172, v172 row_shr:2 row_mask:0xf bank_mask:0xf bound_ctrl:0
    v_add_f32_dpp v174, v174, v174 row_shr:2 row_mask:0xf bank_mask:0xf bound_ctrl:0
    v_add_f32_dpp v168, v168, v168 row_shr:4 row_mask:0xf bank_mask:0xf bound_ctrl:0
    v_add_f32_dpp v170, v170, v170 row_shr:4 row_mask:0xf bank_mask:0xf bound_ctrl:0
    v_add_f32_dpp v172, v172, v172 row_shr:4 row_mask:0xf bank_mask:0xf bound_ctrl:0
    v_add_f32_dpp v174, v174, v174 row_shr:4 row_mask:0xf bank_mask:0xf bound_ctrl:0
    v_add_f32_dpp v168, v168, v168 row_shr:8 row_mask:0xf bank_mask:0xf bound_ctrl:0
    v_add_f32_dpp v170, v170, v170 row_shr:8 row_mask:0xf bank_mask:0xf bound_ctrl:0
    v_add_f32_dpp v172, v172, v172 row_shr:8 row_mask:0xf bank_mask:0xf bound_ctrl:0
    v_add_f32_dpp v174, v174, v174 row_shr:8 row_mask:0xf bank_mask:0xf bound_ctrl:0
    v_add_f32_dpp v168, v168, v168 row_bcast:15 row_mask:0xa bank_mask:0xf
    v_add_f32_dpp v170, v170, v170 row_bcast:15 row_mask:0xa bank_mask:0xf
    v_add_f32_dpp v172, v172, v172 row_bcast:15 row_mask:0xa bank_mask:0xf
    v_add_f32_dpp v174, v174, v174 row_bcast:15 row_mask:0xa bank_mask:0xf
    v_readlane_b32 s92, v168, 31
    v_readlane_b32 s93, v170, 31
    v_readlane_b32 s94, v168, 63
    v_readlane_b32 s95, v170, 63
    v_readlane_b32 s96, v172, 31
    v_readlane_b32 s97, v174, 31
    v_readlane_b32 s98, v172, 63
    v_readlane_b32 s99, v174, 63
    v_add_f32 v200, s92, v200
    v_add_f32 v201, s92, v201
    v_add_f32 v202, s93, v202
    v_add_f32 v203, s93, v203
    v_add_f32 v204, s94, v204
    v_add_f32 v205, s94, v205
    v_add_f32 v206, s95, v206
    v_add_f32 v207, s95, v207
    v_add_f32 v208, s96, v208
    v_add_f32 v209, s96, v209
    v_add_f32 v210, s97, v210
    v_add_f32 v211, s97, v211
    v_add_f32 v212, s98, v212
    v_add_f32 v213, s98, v213
    v_add_f32 v214, s99, v214
    v_add_f32 v215, s99, v215
    s_mov_b32 s31, 1
    s_branch L_layer
L_retry0:
    s_sub_u32 s72, s60, 262144
    s_mov_b32 s73, 0
L_rt0_8:
    buffer_load_dwordx4 v[152:155], v12, s[8:11], s72 offen offset:0 sc1
    buffer_load_dwordx4 v[156:159], v12, s[8:11], s72 offen offset:256 sc1
    buffer_load_dwordx4 v[160:163], v11, s[8:11], s72 offen offset:0 sc1
    buffer_load_dwordx4 v[164:167], v11, s[8:11], s72 offen offset:256 sc1
    buffer_load_dwordx4 v[168:171], v11, s[8:11], s72 offen offset:512 sc1
    buffer_load_dwordx4 v[172:175], v11, s[8:11], s72 offen offset:768 sc1
    buffer_load_dwordx4 v[176:179], v11, s[8:11], s72 offen offset:1024 sc1
    buffer_load_dwordx4 v[180:183], v11, s[8:11], s72 offen offset:1280 sc1
    buffer_load_dwordx4 v[184:187], v11, s[8:11], s72 offen offset:1536 sc1
    buffer_load_dwordx4 v[188:191], v11, s[8:11], s72 offen offset:1792 sc1
    buffer_load_dwordx4 v[192:195], v13, s[8:11], s72 offen offset:0 sc1
    buffer_load_dwordx4 v[196:199], v13, s[8:11], s72 offen offset:256 sc1
    s_waitcnt vmcnt(0)
L_rt0_chk_10:
    v_max3_u32 v0, v152, v156, v160
    v_max3_u32 v0, v0, v164, v168
    v_max3_u32 v0, v0, v172, v176
    v_max3_u32 v0, v0, v180, v184
    v_max3_u32 v0, v0, v188, v192
    v_max_u32 v0, v0, v196
    v_cmp_eq_u32 vcc, -1, v0
    s_add_u32 s73, s73, 1
    s_cmp_eq_u64 vcc, 0
    s_cbranch_scc1 L_rt0_ok_9
    s_sleep 4
    s_cmp_lt_u32 s73, 0x8000
    s_cbranch_scc1 L_rt0_8
L_rt0_ok_9:
    s_branch L_back0
L_retry1:
    s_sub_u32 s72, s60, 262144
    s_mov_b32 s73, 0
L_rt1_11:
    buffer_load_dwordx4 v[104:107], v12, s[8:11], s72 offen offset:0 sc1
    buffer_load_dwordx4 v[108:111], v12, s[8:11], s72 offen offset:256 sc1
    buffer_load_dwordx4 v[112:115], v11, s[8:11], s72 offen offset:0 sc1
    buffer_load_dwordx4 v[116:119], v11, s[8:11], s72 offen offset:256 sc1
    buffer_load_dwordx4 v[120:123], v11, s[8:11], s72 offen offset:512 sc1
    buffer_load_dwordx4 v[124:127], v11, s[8:11], s72 offen offset:768 sc1
    buffer_load_dwordx4 v[128:131], v11, s[8:11], s72 offen offset:1024 sc1
    buffer_load_dwordx4 v[132:135], v11, s[8:11], s72 offen offset:1280 sc1
    buffer_load_dwordx4 v[136:139], v11, s[8:11], s72 offen offset:1536 sc1
    buffer_load_dwordx4 v[140:143], v11, s[8:11], s72 offen offset:1792 sc1
    buffer_load_dwordx4 v[144:147], v13, s[8:11], s72 offen offset:0 sc1
    buffer_load_dwordx4 v[148:151], v13, s[8:11], s72 offen offset:256 sc1
    s_waitcnt vmcnt(0)
L_rt1_chk_13:
    v_max3_u32 v0, v104, v108, v112
    v_max3_u32 v0, v0, v116, v120
    v_max3_u32 v0, v0, v124, v128
    v_max3_u32 v0, v0, v132, v136
    v_max3_u32 v0, v0, v140, v144
    v_max_u32 v0, v0, v148
    v_cmp_eq_u32 vcc, -1, v0
    s_add_u32 s73, s73, 1
    s_cmp_eq_u64 vcc, 0
    s_cbranch_scc1 L_rt1_ok_12
    s_sleep 4
    s_cmp_lt_u32 s73, 0x8000
    s_cbranch_scc1 L_rt1_11
L_rt1_ok_12:
    s_branch L_back1
L_final:
    s_mov_b32 s20, s50
    s_mov_b32 s21, s51
    s_mov_b32 s22, 2097152
    s_mov_b32 s23, 0x00020000
    s_movk_i32 s68, 4096
    s_movk_i32 s69, 8192
    s_movk_i32 s70, 12288
    v_lshlrev_b32 v104, 16, v248
    v_and_b32 v105, 0xffff0000, v248
    v_add_f32 v104, v104, v200
    v_add_f32 v105, v105, v201
    v_cvt_pk_bf16_f32 v120, v104, v105
    buffer_store_dword v120, v15, s[20:23], 0 offen offset:0
    v_lshlrev_b32 v106, 16, v249
    v_and_b32 v107, 0xffff0000, v249
    v_add_f32 v106, v106, v202
    v_add_f32 v107, v107, v203
    v_cvt_pk_bf16_f32 v121, v106, v107
    buffer_store_dword v121, v15, s[20:23], 0 offen offset:2048
    v_lshlrev_b32 v108, 16, v250
    v_and_b32 v109, 0xffff0000, v250
    v_add_f32 v108, v108, v204
    v_add_f32 v109, v109, v205
    v_cvt_pk_bf16_f32 v122, v108, v109
    buffer_store_dword v122, v15, s[20:23], s68 offen offset:0
    v_lshlrev_b32 v110, 16, v251
    v_and_b32 v111, 0xffff0000, v251
    v_add_f32 v110, v110, v206
    v_add_f32 v111, v111, v207
    v_cvt_pk_bf16_f32 v123, v110, v111
    buffer_store_dword v123, v15, s[20:23], s68 offen offset:2048
    v_lshlrev_b32 v112, 16, v252
    v_and_b32 v113, 0xffff0000, v252
    v_add_f32 v112, v112, v208
    v_add_f32 v113, v113, v209
    v_cvt_pk_bf16_f32 v124, v112, v113
    buffer_store_dword v124, v15, s[20:23], s69 offen offset:0
    v_lshlrev_b32 v114, 16, v253
    v_and_b32 v115, 0xffff0000, v253
    v_add_f32 v114, v114, v210
    v_add_f32 v115, v115, v211
    v_cvt_pk_bf16_f32 v125, v114, v115
    buffer_store_dword v125, v15, s[20:23], s69 offen offset:2048
    v_lshlrev_b32 v116, 16, v254
    v_and_b32 v117, 0xffff0000, v254
    v_add_f32 v116, v116, v212
    v_add_f32 v117, v117, v213
    v_cvt_pk_bf16_f32 v126, v116, v117
    buffer_store_dword v126, v15, s[20:23], s70 offen offset:0
    v_lshlrev_b32 v118, 16, v255
    v_and_b32 v119, 0xffff0000, v255
    v_add_f32 v118, v118, v214
    v_add_f32 v119, v119, v215
    v_cvt_pk_bf16_f32 v127, v118, v119
    buffer_store_dword v127, v15, s[20:23], s70 offen offset:2048
    s_lshr_b32 s67, s2, 3
    s_or_b32 s67, s67, s25
    s_or_b32 s67, s67, s3
    s_cmp_lg_u32 s67, 0
    s_cbranch_scc1 L_noep
    s_lshl_b32 s67, s24, 8
    s_add_u32 s67, s67, 8978432
    v_mov_b32 v232, 0
    v_mov_b32 v233, s30
    s_mov_b64 exec, 1
    buffer_store_dword v233, v232, s[16:19], s67 offen
    s_mov_b64 exec, -1
L_noep:
L_exit:
    s_endpgm
L_code_end:
.section .rodata,"a"
.p2align 6
.amdhsa_kernel standalone__adm_resblock__diffusion_kernel
  .amdhsa_next_free_vgpr 324
  .amdhsa_next_free_sgpr 102
  .amdhsa_accum_offset 256
  .amdhsa_group_segment_fixed_size 0
  .amdhsa_kernarg_size 96
  .amdhsa_user_sgpr_count 2
  .amdhsa_user_sgpr_kernarg_segment_ptr 1
  .amdhsa_system_sgpr_workgroup_id_x 1
.end_amdhsa_kernel
```
